```python
import torch

def _softmax(x, axis=-1):
    return torch.softmax(x, dim=axis)
def _gelu(x):
    return torch.nn.functional.gelu(x, approximate="tanh")
def _silu(x):
    return torch.nn.functional.silu(x)
def _sigmoid(x):
    return torch.sigmoid(x)
def _layernorm(x, axis=-1, eps=1e-5):
    m = x.mean(dim=axis, keepdim=True)
    v = x.var(dim=axis, keepdim=True, unbiased=False)
    return (x - m) / torch.sqrt(v + eps)
def _scatter_add(tgt, idx, src, axis=0):
    return tgt.clone().index_add_(axis, idx, src)
def _segment_sum(src, seg, n):
    out = torch.zeros((n,) + src.shape[1:], dtype=src.dtype)
    return out.index_add_(0, seg, src)
def _pad(x, pw):
    flat = tuple(v for pair in reversed(pw) for v in pair)
    return torch.nn.functional.pad(x, flat)

kernel_name = 'recurrent_scan__ssm_conv_s4d__swiglu_ffn__prompt'

def setup_inputs():

    _w = (lambda a: (lambda t: t.to(torch.bfloat16) if t.is_floating_point() else t)(torch.as_tensor(a)))
    def _A_setup():
        Bsz, L, D, N = 1, 2048, 512, 128
        return {
            "u": _w((lambda *s: torch.randn(*s, dtype=torch.bfloat16) * 0.05)(Bsz, L, D)),
            "log_A_real": _w((lambda *s: torch.randn(*s, dtype=torch.bfloat16) * 6.4)(D, N) * 0.5),
            "A_imag": _w((lambda *s: torch.randn(*s, dtype=torch.bfloat16) * 0.05)(D, N) * 3.14),
            "C_real": _w((lambda *s: torch.randn(*s, dtype=torch.bfloat16) * 0.05)(D, N) / N ** 0.5),
            "C_imag": _w((lambda *s: torch.randn(*s, dtype=torch.bfloat16) * 0.05)(D, N) / N ** 0.5),
            "log_dt": _w((lambda *s: torch.randn(*s, dtype=torch.bfloat16) * 0.05)(D) * 0.5 - 4.0),
            "D_skip": _w((lambda *s: torch.randn(*s, dtype=torch.bfloat16) * 0.05)(D)),
        }
    _A_in = _A_setup()

    def _B_setup():
        B, S, D, F = 1, 2048, 512, 1376
        return {
            "x": _w((lambda *s: torch.randn(*s, dtype=torch.bfloat16) * 0.05)(B, S, D)),
            "w_gate": _w((lambda *s: torch.randn(*s, dtype=torch.bfloat16) * 0.05)(D, F)),
            "w_up": _w((lambda *s: torch.randn(*s, dtype=torch.bfloat16) * 0.05)(D, F)),
            "w_down": _w((lambda *s: torch.randn(*s, dtype=torch.bfloat16) * 0.05)(F, D)),
        }
    _B_in = _B_setup()

    return {
        "A_u": _A_in["u"],
        "A_log_A_real": _A_in["log_A_real"],
        "A_A_imag": _A_in["A_imag"],
        "A_C_real": _A_in["C_real"],
        "A_C_imag": _A_in["C_imag"],
        "A_log_dt": _A_in["log_dt"],
        "A_D_skip": _A_in["D_skip"],
        "B_x": _B_in["x"],
        "B_w_gate": _B_in["w_gate"],
        "B_w_up": _B_in["w_up"],
        "B_w_down": _B_in["w_down"],
    }

def reference(A_u, A_log_A_real, A_A_imag, A_C_real, A_C_imag, A_log_dt, A_D_skip, B_x, B_w_gate, B_w_up, B_w_down):
    def _A_ref(u, log_A_real, A_imag, C_real, C_imag, log_dt, D_skip):
        L = u.shape[1]
        dt = torch.exp(log_dt)
        A = -torch.exp(log_A_real) + 1j * A_imag
        C = (C_real + 1j * C_imag) * dt[:, None]
        pos = (lambda x, dt: x.to(dt))(torch.arange(L), log_dt.dtype)
        P = torch.exp((A * dt[:, None])[:, :, None] * pos[None, None, :])
        K = 2.0 * torch.einsum("dn,dnl->dl", C, P).real
        L2 = 2 * L
        u_t = (lambda x, *d: x.permute(*d))(u, 0, 2, 1)
        Kf = (lambda x, *a, **k: torch.fft.rfft(x.float(), *a, **k))(K, L2)
        Uf = (lambda x, *a, **k: torch.fft.rfft(x.float(), *a, **k))(u_t, L2)
        y = (lambda x, *a, **k: torch.fft.irfft(x, *a, **k).to(torch.bfloat16))(Uf * Kf[None, :, :], L2)[:, :, :L]
        y = (lambda x, *d: x.permute(*d))(y, 0, 2, 1)
        return y + u * D_skip[None, None, :]

    def _B_ref(x, w_gate, w_up, w_down):
        g = _silu(x @ w_gate)
        u = x @ w_up
        return (g * u) @ w_down

    x = A_u
    xn = _layernorm(x, axis=-1)
    s = _A_ref(xn, A_log_A_real, A_A_imag, A_C_real, A_C_imag, A_log_dt, A_D_skip)
    g = _silu(_B_ref(xn, B_w_gate, B_w_up, B_w_down))
    return x + s * g
```

```asm
; @launch grid=(256,1,1) block=(640,1,1) lds=163840
.amdgcn_target "amdgcn-amd-amdhsa--gfx950"
.text
.globl recurrent_scan__ssm_conv_s4d__swiglu_ffn__prompt_kernel
.p2align 8
.type recurrent_scan__ssm_conv_s4d__swiglu_ffn__prompt_kernel,@function
recurrent_scan__ssm_conv_s4d__swiglu_ffn__prompt_kernel:
    s_cmp_ge_u32 s2, 256
    s_cbranch_scc1 L_exit
    s_load_dwordx16 s[16:31], s[0:1], 0
    s_load_dwordx8 s[32:39], s[0:1], 64
    s_load_dwordx4 s[40:43], s[0:1], 96
    v_lshrrev_b32 v2, 6, v0
    v_and_b32 v1, 63, v0
    v_readfirstlane_b32 s3, v2
    s_and_b32 s69, s2, 7
    s_lshr_b32 s70, s2, 3
    v_mov_b32 v2, 163328
    s_cmp_lg_u32 s3, 0
    s_cbranch_scc1 L_pfdone
    s_getpc_b64 s[4:5]
L_pc:
    v_and_b32 v3, 15, v1
    v_lshlrev_b32 v3, 5, v3
    v_add_u32 v3, s70, v3
    v_lshlrev_b32 v3, 7, v3
    v_min_u32 v3, L_end-L_pc-4, v3
    global_load_dword v167, v3, s[4:5]
    v_lshl_add_u32 v3, v1, 2, v2
    v_mov_b32 v4, 0
    ds_write_b32 v3, v4
L_pfdone:
    s_and_b32 s4, s69, 3
    s_mul_i32 s5, s4, 28
    s_add_u32 s5, s5, s70
    s_lshl_b32 s6, s4, 1
    s_add_u32 s6, s6, s70
    s_add_u32 s6, s6, 84
    s_cmp_lt_u32 s70, 28
    s_cselect_b32 s5, s5, s6
    s_cselect_b32 s74, 0, 1
    s_cmp_lt_u32 s70, 30
    s_cselect_b32 s74, s74, 2
    s_cselect_b32 s5, s5, 112
    s_lshr_b32 s72, s5, 3
    s_and_b32 s5, s5, 7
    s_lshr_b32 s4, s69, 2
    s_lshl_b32 s4, s4, 3
    s_add_u32 s71, s4, s5
    s_mul_i32 s73, s72, 3
    s_lshl_b32 s4, s69, 5
    s_add_u32 s75, s4, s70
    s_mov_b32 s46, 2097152
    s_mov_b32 s47, 0x20000
    s_mov_b32 s50, 1409024
    s_mov_b32 s51, 0x20000
    s_mov_b32 s54, 1409024
    s_mov_b32 s55, 0x20000
    s_mov_b32 s58, 1409024
    s_mov_b32 s59, 0x20000
    s_mov_b32 s62, 2097152
    s_mov_b32 s63, 0x20000
    s_mov_b32 s66, 268435456
    s_mov_b32 s67, 0x20000
    v_lshrrev_b32 v3, 3, v1
    v_lshlrev_b32 v3, 10, v3
    v_and_b32 v4, 7, v1
    v_lshrrev_b32 v5, 4, v1
    v_xor_b32 v5, v4, v5
    v_lshl_add_u32 v8, v5, 4, v3
    v_xor_b32 v9, 64, v8
    v_add_u32 v9, 7168, v9
    v_add_u32 v10, 14336, v8
    v_add_u32 v11, 14336, v9
    v_bfe_u32 v5, v1, 4, 1
    v_lshlrev_b32 v5, 2, v5
    v_xor_b32 v4, v4, v5
    v_lshl_add_u32 v16, v4, 4, v3
    v_lshrrev_b32 v6, 2, v1
    v_mul_u32_u24 v6, 2752, v6
    v_and_b32 v7, 3, v1
    v_lshl_add_u32 v12, v7, 4, v6
    v_xor_b32 v7, 2, v7
    v_lshl_add_u32 v13, v7, 4, v6
    s_add_u32 s10, s71, s72
    s_and_b32 s10, s10, 3
    s_lshl_b32 s10, s10, 1
    s_lshr_b32 s4, s71, 3
    s_lshr_b32 s5, s72, 2
    s_add_u32 s5, s5, s4
    s_and_b32 s5, s5, 1
    s_add_u32 s10, s10, s5
    s_lshl_b32 s6, s71, 17
    s_lshl_b32 s7, s73, 6
    s_lshl_b32 s11, s10, 7
    s_add_u32 s11, s11, s6
    s_mul_i32 s12, s10, 176128
    s_add_u32 s12, s12, s7
    s_and_b32 s14, s3, 1
    s_lshr_b32 s15, s3, 1
    s_lshl_b32 s4, s75, 1
    s_add_u32 s4, s4, s14
    s_lshl_b32 s4, s4, 8
    s_lshl_b32 s5, s15, 7
    s_add_u32 s4, s4, s5
    v_lshl_add_u32 v3, v1, 1, s4
    v_lshlrev_b32 v5, 4, v1
    s_lshl_b32 s13, s75, 13
    s_mov_b32 m0, 152064
    s_waitcnt lgkmcnt(0)
    s_mov_b64 s[44:45], s[16:17]
    s_mov_b64 s[48:49], s[32:33]
    s_mov_b64 s[52:53], s[34:35]
    s_mov_b64 s[56:57], s[36:37]
    s_mov_b64 s[60:61], s[38:39]
    s_mov_b64 s[64:65], s[42:43]
    s_cmp_eq_u32 s3, 5
    s_cbranch_scc1 L_B
    s_cmp_ge_u32 s3, 4
    s_cbranch_scc1 L_notH
    global_load_ushort v24, v3, s[18:19]
    global_load_ushort v25, v3, s[20:21]
    global_load_ushort v26, v3, s[22:23]
    global_load_ushort v27, v3, s[24:25]
    s_lshl_b32 s4, s75, 2
    s_load_dword s68, s[42:43], 0
    s_load_dword s76, s[26:27], s4
    s_load_dword s77, s[28:29], s4
    s_branch L_H
L_notH:
    s_load_dword s68, s[42:43], 0
    s_cmp_gt_u32 s3, 4
    s_cbranch_scc1 L_G
    buffer_load_dwordx4 v5, s[44:47], s13 offen lds
    s_mov_b32 m0, 153120
    s_add_u32 s13, s13, 1024
    buffer_load_dwordx4 v5, s[44:47], s13 offen lds
    s_mov_b32 m0, 154176
    s_add_u32 s13, s13, 1024
    buffer_load_dwordx4 v5, s[44:47], s13 offen lds
    s_mov_b32 m0, 155232
    s_add_u32 s13, s13, 1024
    buffer_load_dwordx4 v5, s[44:47], s13 offen lds
    s_mov_b32 m0, 156288
    s_add_u32 s13, s13, 1024
    buffer_load_dwordx4 v5, s[44:47], s13 offen lds
    s_mov_b32 m0, 157344
    s_add_u32 s13, s13, 1024
    buffer_load_dwordx4 v5, s[44:47], s13 offen lds
    s_mov_b32 m0, 158400
    s_add_u32 s13, s13, 1024
    buffer_load_dwordx4 v5, s[44:47], s13 offen lds
    s_mov_b32 m0, 159456
    s_add_u32 s13, s13, 1024
    buffer_load_dwordx4 v5, s[44:47], s13 offen lds
    s_branch L_A
L_B:
    s_setprio 3
    s_cmp_eq_u32 s74, 2
    s_cbranch_scc1 L_Bidle
    s_mov_b32 m0, 0
    s_add_u32 s8, s11, 0
    buffer_load_dwordx4 v8, s[44:47], s8 offen offset:0 lds
    buffer_load_dwordx4 v9, s[44:47], s8 offen offset:1024 lds
    buffer_load_dwordx4 v10, s[44:47], s8 offen offset:2048 lds
    buffer_load_dwordx4 v11, s[44:47], s8 offen offset:3072 lds
    s_mov_b32 m0, 4096
    s_add_u32 s8, s11, 32768
    buffer_load_dwordx4 v8, s[44:47], s8 offen offset:0 lds
    buffer_load_dwordx4 v9, s[44:47], s8 offen offset:1024 lds
    buffer_load_dwordx4 v10, s[44:47], s8 offen offset:2048 lds
    buffer_load_dwordx4 v11, s[44:47], s8 offen offset:3072 lds
    s_mov_b32 m0, 8192
    s_add_u32 s8, s11, 65536
    buffer_load_dwordx4 v8, s[44:47], s8 offen offset:0 lds
    buffer_load_dwordx4 v9, s[44:47], s8 offen offset:1024 lds
    buffer_load_dwordx4 v10, s[44:47], s8 offen offset:2048 lds
    buffer_load_dwordx4 v11, s[44:47], s8 offen offset:3072 lds
    s_mov_b32 m0, 12288
    s_add_u32 s8, s11, 98304
    buffer_load_dwordx4 v8, s[44:47], s8 offen offset:0 lds
    buffer_load_dwordx4 v9, s[44:47], s8 offen offset:1024 lds
    buffer_load_dwordx4 v10, s[44:47], s8 offen offset:2048 lds
    buffer_load_dwordx4 v11, s[44:47], s8 offen offset:3072 lds
    s_mov_b32 m0, 16384
    s_add_u32 s8, s12, 0
    buffer_load_dwordx4 v12, s[48:51], s8 offen offset:0 lds
    s_mov_b32 m0, 17344
    s_add_u32 s10, s10, 1
    buffer_load_dwordx4 v12, s[48:51], s8 offen offset:64 lds
    s_mov_b32 m0, 18304
    s_and_b32 s10, s10, 7
    buffer_load_dwordx4 v12, s[48:51], s8 offen offset:128 lds
    s_mov_b32 m0, 28672
    s_lshl_b32 s11, s10, 7
    buffer_load_dwordx4 v13, s[52:55], s8 offen offset:0 lds
    s_mov_b32 m0, 29632
    s_add_u32 s11, s11, s6
    buffer_load_dwordx4 v13, s[52:55], s8 offen offset:64 lds
    s_mov_b32 m0, 30592
    s_nop 0
    buffer_load_dwordx4 v13, s[52:55], s8 offen offset:128 lds
    v_add_u32 v17, 7168, v16
    v_add_u32 v18, 14336, v16
    v_add_u32 v19, 21504, v16
    s_lshr_b32 s9, s70, 2
    s_lshl_b32 s9, s9, 7
    s_barrier
    s_mov_b32 m0, 19456
    s_add_u32 s8, s12, 44032
    buffer_load_dwordx4 v12, s[48:51], s8 offen offset:0 lds
    s_mov_b32 m0, 20416
    s_nop 0
    buffer_load_dwordx4 v12, s[48:51], s8 offen offset:64 lds
    s_mov_b32 m0, 21376
    s_nop 0
    buffer_load_dwordx4 v12, s[48:51], s8 offen offset:128 lds
    s_mov_b32 m0, 31744
    s_nop 0
    buffer_load_dwordx4 v13, s[52:55], s8 offen offset:0 lds
    s_mov_b32 m0, 32704
    s_nop 0
    buffer_load_dwordx4 v13, s[52:55], s8 offen offset:64 lds
    s_mov_b32 m0, 33664
    s_nop 0
    buffer_load_dwordx4 v13, s[52:55], s8 offen offset:128 lds
    s_mov_b32 m0, 22528
    s_add_u32 s8, s12, 88064
    buffer_load_dwordx4 v12, s[48:51], s8 offen offset:0 lds
    s_mov_b32 m0, 23488
    s_nop 0
    buffer_load_dwordx4 v12, s[48:51], s8 offen offset:64 lds
    s_mov_b32 m0, 24448
    s_nop 0
    buffer_load_dwordx4 v12, s[48:51], s8 offen offset:128 lds
    s_mov_b32 m0, 34816
    s_nop 0
    buffer_load_dwordx4 v13, s[52:55], s8 offen offset:0 lds
    s_mov_b32 m0, 35776
    s_nop 0
    buffer_load_dwordx4 v13, s[52:55], s8 offen offset:64 lds
    s_mov_b32 m0, 36736
    s_nop 0
    buffer_load_dwordx4 v13, s[52:55], s8 offen offset:128 lds
    s_mov_b32 m0, 25600
    s_add_u32 s8, s12, 132096
    buffer_load_dwordx4 v12, s[48:51], s8 offen offset:0 lds
    s_mov_b32 m0, 26560
    s_mul_i32 s12, s10, 176128
    buffer_load_dwordx4 v12, s[48:51], s8 offen offset:64 lds
    s_mov_b32 m0, 27520
    s_add_u32 s12, s12, s7
    buffer_load_dwordx4 v12, s[48:51], s8 offen offset:128 lds
    s_mov_b32 m0, 37888
    s_nop 0
    buffer_load_dwordx4 v13, s[52:55], s8 offen offset:0 lds
    s_mov_b32 m0, 38848
    s_nop 0
    buffer_load_dwordx4 v13, s[52:55], s8 offen offset:64 lds
    s_mov_b32 m0, 39808
    s_nop 0
    buffer_load_dwordx4 v13, s[52:55], s8 offen offset:128 lds
    s_mov_b32 m0, 45056
    s_add_u32 s8, s11, 0
    buffer_load_dwordx4 v8, s[44:47], s8 offen offset:0 lds
    buffer_load_dwordx4 v9, s[44:47], s8 offen offset:1024 lds
    buffer_load_dwordx4 v10, s[44:47], s8 offen offset:2048 lds
    buffer_load_dwordx4 v11, s[44:47], s8 offen offset:3072 lds
    s_mov_b32 m0, 49152
    s_add_u32 s8, s11, 32768
    buffer_load_dwordx4 v8, s[44:47], s8 offen offset:0 lds
    buffer_load_dwordx4 v9, s[44:47], s8 offen offset:1024 lds
    buffer_load_dwordx4 v10, s[44:47], s8 offen offset:2048 lds
    buffer_load_dwordx4 v11, s[44:47], s8 offen offset:3072 lds
    s_mov_b32 m0, 53248
    s_add_u32 s8, s11, 65536
    buffer_load_dwordx4 v8, s[44:47], s8 offen offset:0 lds
    buffer_load_dwordx4 v9, s[44:47], s8 offen offset:1024 lds
    buffer_load_dwordx4 v10, s[44:47], s8 offen offset:2048 lds
    buffer_load_dwordx4 v11, s[44:47], s8 offen offset:3072 lds
    s_mov_b32 m0, 57344
    s_add_u32 s8, s11, 98304
    buffer_load_dwordx4 v8, s[44:47], s8 offen offset:0 lds
    buffer_load_dwordx4 v9, s[44:47], s8 offen offset:1024 lds
    buffer_load_dwordx4 v10, s[44:47], s8 offen offset:2048 lds
    buffer_load_dwordx4 v11, s[44:47], s8 offen offset:3072 lds
    s_mov_b32 m0, 61440
    s_add_u32 s8, s12, 0
    buffer_load_dwordx4 v12, s[48:51], s8 offen offset:0 lds
    s_mov_b32 m0, 62400
    s_add_u32 s10, s10, 1
    buffer_load_dwordx4 v12, s[48:51], s8 offen offset:64 lds
    s_mov_b32 m0, 63360
    s_and_b32 s10, s10, 7
    buffer_load_dwordx4 v12, s[48:51], s8 offen offset:128 lds
    s_mov_b32 m0, 73728
    s_lshl_b32 s11, s10, 7
    buffer_load_dwordx4 v13, s[52:55], s8 offen offset:0 lds
    s_mov_b32 m0, 74688
    s_add_u32 s11, s11, s6
    buffer_load_dwordx4 v13, s[52:55], s8 offen offset:64 lds
    s_mov_b32 m0, 75648
    s_nop 0
    buffer_load_dwordx4 v13, s[52:55], s8 offen offset:128 lds
    s_waitcnt vmcnt(34)
    v_mov_b32 v24, 2
    ds_write_b32 v2, v24 offset:0
    s_mov_b32 m0, 64512
    s_add_u32 s8, s12, 44032
    buffer_load_dwordx4 v12, s[48:51], s8 offen offset:0 lds
    s_mov_b32 m0, 65472
    s_nop 0
    buffer_load_dwordx4 v12, s[48:51], s8 offen offset:64 lds
    s_mov_b32 m0, 66432
    s_nop 0
    buffer_load_dwordx4 v12, s[48:51], s8 offen offset:128 lds
    s_mov_b32 m0, 76800
    s_nop 0
    buffer_load_dwordx4 v13, s[52:55], s8 offen offset:0 lds
    s_mov_b32 m0, 77760
    s_nop 0
    buffer_load_dwordx4 v13, s[52:55], s8 offen offset:64 lds
    s_mov_b32 m0, 78720
    s_nop 0
    buffer_load_dwordx4 v13, s[52:55], s8 offen offset:128 lds
    s_mov_b32 m0, 67584
    s_add_u32 s8, s12, 88064
    buffer_load_dwordx4 v12, s[48:51], s8 offen offset:0 lds
    s_mov_b32 m0, 68544
    s_nop 0
    buffer_load_dwordx4 v12, s[48:51], s8 offen offset:64 lds
    s_mov_b32 m0, 69504
    s_nop 0
    buffer_load_dwordx4 v12, s[48:51], s8 offen offset:128 lds
    s_mov_b32 m0, 79872
    s_nop 0
    buffer_load_dwordx4 v13, s[52:55], s8 offen offset:0 lds
    s_mov_b32 m0, 80832
    s_nop 0
    buffer_load_dwordx4 v13, s[52:55], s8 offen offset:64 lds
    s_mov_b32 m0, 81792
    s_nop 0
    buffer_load_dwordx4 v13, s[52:55], s8 offen offset:128 lds
    s_waitcnt vmcnt(34)
    v_mov_b32 v24, 4
    ds_write_b32 v2, v24 offset:0
    s_mov_b32 m0, 70656
    s_add_u32 s8, s12, 132096
    buffer_load_dwordx4 v12, s[48:51], s8 offen offset:0 lds
    s_mov_b32 m0, 71616
    s_mul_i32 s12, s10, 176128
    buffer_load_dwordx4 v12, s[48:51], s8 offen offset:64 lds
    s_mov_b32 m0, 72576
    s_add_u32 s12, s12, s7
    buffer_load_dwordx4 v12, s[48:51], s8 offen offset:128 lds
    s_mov_b32 m0, 82944
    s_nop 0
    buffer_load_dwordx4 v13, s[52:55], s8 offen offset:0 lds
    s_mov_b32 m0, 83904
    s_nop 0
    buffer_load_dwordx4 v13, s[52:55], s8 offen offset:64 lds
    s_mov_b32 m0, 84864
    s_nop 0
    buffer_load_dwordx4 v13, s[52:55], s8 offen offset:128 lds
    s_mov_b32 m0, 90112
    s_add_u32 s8, s11, 0
    buffer_load_dwordx4 v8, s[44:47], s8 offen offset:0 lds
    buffer_load_dwordx4 v9, s[44:47], s8 offen offset:1024 lds
    buffer_load_dwordx4 v10, s[44:47], s8 offen offset:2048 lds
    buffer_load_dwordx4 v11, s[44:47], s8 offen offset:3072 lds
    s_mov_b32 m0, 94208
    s_add_u32 s8, s11, 32768
    buffer_load_dwordx4 v8, s[44:47], s8 offen offset:0 lds
    buffer_load_dwordx4 v9, s[44:47], s8 offen offset:1024 lds
    buffer_load_dwordx4 v10, s[44:47], s8 offen offset:2048 lds
    buffer_load_dwordx4 v11, s[44:47], s8 offen offset:3072 lds
    s_mov_b32 m0, 98304
    s_add_u32 s8, s11, 65536
    buffer_load_dwordx4 v8, s[44:47], s8 offen offset:0 lds
    buffer_load_dwordx4 v9, s[44:47], s8 offen offset:1024 lds
    buffer_load_dwordx4 v10, s[44:47], s8 offen offset:2048 lds
    buffer_load_dwordx4 v11, s[44:47], s8 offen offset:3072 lds
    s_mov_b32 m0, 102400
    s_add_u32 s8, s11, 98304
    buffer_load_dwordx4 v8, s[44:47], s8 offen offset:0 lds
    buffer_load_dwordx4 v9, s[44:47], s8 offen offset:1024 lds
    buffer_load_dwordx4 v10, s[44:47], s8 offen offset:2048 lds
    buffer_load_dwordx4 v11, s[44:47], s8 offen offset:3072 lds
    s_mov_b32 m0, 106496
    s_add_u32 s8, s12, 0
    buffer_load_dwordx4 v12, s[48:51], s8 offen offset:0 lds
    s_mov_b32 m0, 107456
    s_add_u32 s10, s10, 1
    buffer_load_dwordx4 v12, s[48:51], s8 offen offset:64 lds
    s_mov_b32 m0, 108416
    s_and_b32 s10, s10, 7
    buffer_load_dwordx4 v12, s[48:51], s8 offen offset:128 lds
    s_mov_b32 m0, 118784
    s_lshl_b32 s11, s10, 7
    buffer_load_dwordx4 v13, s[52:55], s8 offen offset:0 lds
    s_mov_b32 m0, 119744
    s_add_u32 s11, s11, s6
    buffer_load_dwordx4 v13, s[52:55], s8 offen offset:64 lds
    s_mov_b32 m0, 120704
    s_nop 0
    buffer_load_dwordx4 v13, s[52:55], s8 offen offset:128 lds
    s_waitcnt vmcnt(34)
    v_mov_b32 v24, 6
    ds_write_b32 v2, v24 offset:0
    s_mov_b32 m0, 109568
    s_add_u32 s8, s12, 44032
    buffer_load_dwordx4 v12, s[48:51], s8 offen offset:0 lds
    s_mov_b32 m0, 110528
    s_nop 0
    buffer_load_dwordx4 v12, s[48:51], s8 offen offset:64 lds
    s_mov_b32 m0, 111488
    s_nop 0
    buffer_load_dwordx4 v12, s[48:51], s8 offen offset:128 lds
    s_mov_b32 m0, 121856
    s_nop 0
    buffer_load_dwordx4 v13, s[52:55], s8 offen offset:0 lds
    s_mov_b32 m0, 122816
    s_nop 0
    buffer_load_dwordx4 v13, s[52:55], s8 offen offset:64 lds
    s_mov_b32 m0, 123776
    s_nop 0
    buffer_load_dwordx4 v13, s[52:55], s8 offen offset:128 lds
    s_mov_b32 m0, 112640
    s_add_u32 s8, s12, 88064
    buffer_load_dwordx4 v12, s[48:51], s8 offen offset:0 lds
    s_mov_b32 m0, 113600
    ds_read_b128 v[20:23], v2 offset:16
    buffer_load_dwordx4 v12, s[48:51], s8 offen offset:64 lds
    s_mov_b32 m0, 114560
    s_nop 0
    buffer_load_dwordx4 v12, s[48:51], s8 offen offset:128 lds
    s_mov_b32 m0, 124928
    s_nop 0
    buffer_load_dwordx4 v13, s[52:55], s8 offen offset:0 lds
    s_mov_b32 m0, 125888
    s_nop 0
    buffer_load_dwordx4 v13, s[52:55], s8 offen offset:64 lds
    s_mov_b32 m0, 126848
    s_nop 0
    buffer_load_dwordx4 v13, s[52:55], s8 offen offset:128 lds
    s_waitcnt vmcnt(34)
    v_mov_b32 v24, 8
    ds_write_b32 v2, v24 offset:0
    s_mov_b32 m0, 115712
    s_add_u32 s8, s12, 132096
    buffer_load_dwordx4 v12, s[48:51], s8 offen offset:0 lds
    s_mov_b32 m0, 116672
    s_mul_i32 s12, s10, 176128
    buffer_load_dwordx4 v12, s[48:51], s8 offen offset:64 lds
    s_mov_b32 m0, 117632
    s_add_u32 s12, s12, s7
    buffer_load_dwordx4 v12, s[48:51], s8 offen offset:128 lds
    s_mov_b32 m0, 128000
    s_waitcnt lgkmcnt(1)
    v_min3_u32 v20, v20, v21, v22
    v_min_u32 v20, v20, v23
    buffer_load_dwordx4 v13, s[52:55], s8 offen offset:0 lds
    s_mov_b32 m0, 128960
    s_nop 0
    buffer_load_dwordx4 v13, s[52:55], s8 offen offset:64 lds
    s_mov_b32 m0, 129920
    v_readfirstlane_b32 s13, v20
    buffer_load_dwordx4 v13, s[52:55], s8 offen offset:128 lds
    s_cmp_lt_u32 s13, 1
    s_cbranch_scc1 Lbs1
Lbr2:
    s_mov_b32 m0, 0
    s_add_u32 s8, s11, 0
    buffer_load_dwordx4 v8, s[44:47], s8 offen offset:0 lds
    buffer_load_dwordx4 v9, s[44:47], s8 offen offset:1024 lds
    buffer_load_dwordx4 v10, s[44:47], s8 offen offset:2048 lds
    buffer_load_dwordx4 v11, s[44:47], s8 offen offset:3072 lds
    s_mov_b32 m0, 4096
    s_add_u32 s8, s11, 32768
    buffer_load_dwordx4 v8, s[44:47], s8 offen offset:0 lds
    buffer_load_dwordx4 v9, s[44:47], s8 offen offset:1024 lds
    buffer_load_dwordx4 v10, s[44:47], s8 offen offset:2048 lds
    buffer_load_dwordx4 v11, s[44:47], s8 offen offset:3072 lds
    s_mov_b32 m0, 8192
    s_add_u32 s8, s11, 65536
    buffer_load_dwordx4 v8, s[44:47], s8 offen offset:0 lds
    buffer_load_dwordx4 v9, s[44:47], s8 offen offset:1024 lds
    buffer_load_dwordx4 v10, s[44:47], s8 offen offset:2048 lds
    buffer_load_dwordx4 v11, s[44:47], s8 offen offset:3072 lds
    s_mov_b32 m0, 12288
    s_add_u32 s8, s11, 98304
    buffer_load_dwordx4 v8, s[44:47], s8 offen offset:0 lds
    buffer_load_dwordx4 v9, s[44:47], s8 offen offset:1024 lds
    buffer_load_dwordx4 v10, s[44:47], s8 offen offset:2048 lds
    buffer_load_dwordx4 v11, s[44:47], s8 offen offset:3072 lds
    s_mov_b32 m0, 16384
    s_add_u32 s8, s12, 0
    buffer_load_dwordx4 v12, s[48:51], s8 offen offset:0 lds
    s_mov_b32 m0, 17344
    s_add_u32 s10, s10, 1
    buffer_load_dwordx4 v12, s[48:51], s8 offen offset:64 lds
    s_mov_b32 m0, 18304
    s_and_b32 s10, s10, 7
    buffer_load_dwordx4 v12, s[48:51], s8 offen offset:128 lds
    s_mov_b32 m0, 28672
    s_lshl_b32 s11, s10, 7
    buffer_load_dwordx4 v13, s[52:55], s8 offen offset:0 lds
    s_mov_b32 m0, 29632
    s_add_u32 s11, s11, s6
    buffer_load_dwordx4 v13, s[52:55], s8 offen offset:64 lds
    s_mov_b32 m0, 30592
    s_nop 0
    buffer_load_dwordx4 v13, s[52:55], s8 offen offset:128 lds
    s_waitcnt vmcnt(34)
    v_mov_b32 v24, 10
    ds_write_b32 v2, v24 offset:0
    s_mov_b32 m0, 19456
    s_add_u32 s8, s12, 44032
    buffer_load_dwordx4 v12, s[48:51], s8 offen offset:0 lds
    s_mov_b32 m0, 20416
    s_nop 0
    buffer_load_dwordx4 v12, s[48:51], s8 offen offset:64 lds
    s_mov_b32 m0, 21376
    s_nop 0
    buffer_load_dwordx4 v12, s[48:51], s8 offen offset:128 lds
    s_mov_b32 m0, 31744
    s_nop 0
    buffer_load_dwordx4 v13, s[52:55], s8 offen offset:0 lds
    s_mov_b32 m0, 32704
    s_nop 0
    buffer_load_dwordx4 v13, s[52:55], s8 offen offset:64 lds
    s_mov_b32 m0, 33664
    s_nop 0
    buffer_load_dwordx4 v13, s[52:55], s8 offen offset:128 lds
    s_mov_b32 m0, 22528
    s_add_u32 s8, s12, 88064
    buffer_load_dwordx4 v12, s[48:51], s8 offen offset:0 lds
    s_mov_b32 m0, 23488
    ds_read_b128 v[20:23], v2 offset:16
    buffer_load_dwordx4 v12, s[48:51], s8 offen offset:64 lds
    s_mov_b32 m0, 24448
    s_nop 0
    buffer_load_dwordx4 v12, s[48:51], s8 offen offset:128 lds
    s_mov_b32 m0, 34816
    s_nop 0
    buffer_load_dwordx4 v13, s[52:55], s8 offen offset:0 lds
    s_mov_b32 m0, 35776
    s_nop 0
    buffer_load_dwordx4 v13, s[52:55], s8 offen offset:64 lds
    s_mov_b32 m0, 36736
    s_nop 0
    buffer_load_dwordx4 v13, s[52:55], s8 offen offset:128 lds
    s_waitcnt vmcnt(34)
    v_mov_b32 v24, 12
    ds_write_b32 v2, v24 offset:0
    s_mov_b32 m0, 25600
    s_add_u32 s8, s12, 132096
    buffer_load_dwordx4 v12, s[48:51], s8 offen offset:0 lds
    s_mov_b32 m0, 26560
    s_mul_i32 s12, s10, 176128
    buffer_load_dwordx4 v12, s[48:51], s8 offen offset:64 lds
    s_mov_b32 m0, 27520
    s_add_u32 s12, s12, s7
    buffer_load_dwordx4 v12, s[48:51], s8 offen offset:128 lds
    s_mov_b32 m0, 37888
    s_waitcnt lgkmcnt(1)
    v_min3_u32 v20, v20, v21, v22
    v_min_u32 v20, v20, v23
    buffer_load_dwordx4 v13, s[52:55], s8 offen offset:0 lds
    s_mov_b32 m0, 38848
    s_nop 0
    buffer_load_dwordx4 v13, s[52:55], s8 offen offset:64 lds
    s_mov_b32 m0, 39808
    v_readfirstlane_b32 s13, v20
    buffer_load_dwordx4 v13, s[52:55], s8 offen offset:128 lds
    s_cmp_lt_u32 s13, 2
    s_cbranch_scc1 Lbs5
Lbr6:
    s_mov_b32 m0, 45056
    s_add_u32 s8, s11, 0
    buffer_load_dwordx4 v8, s[44:47], s8 offen offset:0 lds
    buffer_load_dwordx4 v9, s[44:47], s8 offen offset:1024 lds
    buffer_load_dwordx4 v10, s[44:47], s8 offen offset:2048 lds
    buffer_load_dwordx4 v11, s[44:47], s8 offen offset:3072 lds
    s_mov_b32 m0, 49152
    s_add_u32 s8, s11, 32768
    buffer_load_dwordx4 v8, s[44:47], s8 offen offset:0 lds
    buffer_load_dwordx4 v9, s[44:47], s8 offen offset:1024 lds
    buffer_load_dwordx4 v10, s[44:47], s8 offen offset:2048 lds
    buffer_load_dwordx4 v11, s[44:47], s8 offen offset:3072 lds
    s_mov_b32 m0, 53248
    s_add_u32 s8, s11, 65536
    buffer_load_dwordx4 v8, s[44:47], s8 offen offset:0 lds
    buffer_load_dwordx4 v9, s[44:47], s8 offen offset:1024 lds
    buffer_load_dwordx4 v10, s[44:47], s8 offen offset:2048 lds
    buffer_load_dwordx4 v11, s[44:47], s8 offen offset:3072 lds
    s_mov_b32 m0, 57344
    s_add_u32 s8, s11, 98304
    buffer_load_dwordx4 v8, s[44:47], s8 offen offset:0 lds
    buffer_load_dwordx4 v9, s[44:47], s8 offen offset:1024 lds
    buffer_load_dwordx4 v10, s[44:47], s8 offen offset:2048 lds
    buffer_load_dwordx4 v11, s[44:47], s8 offen offset:3072 lds
    s_mov_b32 m0, 61440
    s_add_u32 s8, s12, 0
    buffer_load_dwordx4 v12, s[48:51], s8 offen offset:0 lds
    s_mov_b32 m0, 62400
    s_add_u32 s10, s10, 1
    buffer_load_dwordx4 v12, s[48:51], s8 offen offset:64 lds
    s_mov_b32 m0, 63360
    s_and_b32 s10, s10, 7
    buffer_load_dwordx4 v12, s[48:51], s8 offen offset:128 lds
    s_mov_b32 m0, 73728
    s_lshl_b32 s11, s10, 7
    buffer_load_dwordx4 v13, s[52:55], s8 offen offset:0 lds
    s_mov_b32 m0, 74688
    s_add_u32 s11, s11, s6
    buffer_load_dwordx4 v13, s[52:55], s8 offen offset:64 lds
    s_mov_b32 m0, 75648
    s_nop 0
    buffer_load_dwordx4 v13, s[52:55], s8 offen offset:128 lds
    s_waitcnt vmcnt(34)
    v_mov_b32 v24, 14
    ds_write_b32 v2, v24 offset:0
    s_mov_b32 m0, 64512
    s_add_u32 s8, s12, 44032
    buffer_load_dwordx4 v12, s[48:51], s8 offen offset:0 lds
    s_mov_b32 m0, 65472
    s_nop 0
    buffer_load_dwordx4 v12, s[48:51], s8 offen offset:64 lds
    s_mov_b32 m0, 66432
    s_nop 0
    buffer_load_dwordx4 v12, s[48:51], s8 offen offset:128 lds
    s_mov_b32 m0, 76800
    s_nop 0
    buffer_load_dwordx4 v13, s[52:55], s8 offen offset:0 lds
    s_mov_b32 m0, 77760
    s_nop 0
    buffer_load_dwordx4 v13, s[52:55], s8 offen offset:64 lds
    s_mov_b32 m0, 78720
    s_nop 0
    buffer_load_dwordx4 v13, s[52:55], s8 offen offset:128 lds
    s_mov_b32 m0, 67584
    s_add_u32 s8, s12, 88064
    buffer_load_dwordx4 v12, s[48:51], s8 offen offset:0 lds
    s_mov_b32 m0, 68544
    ds_read_b128 v[20:23], v2 offset:16
    buffer_load_dwordx4 v12, s[48:51], s8 offen offset:64 lds
    s_mov_b32 m0, 69504
    s_nop 0
    buffer_load_dwordx4 v12, s[48:51], s8 offen offset:128 lds
    s_mov_b32 m0, 79872
    s_nop 0
    buffer_load_dwordx4 v13, s[52:55], s8 offen offset:0 lds
    s_mov_b32 m0, 80832
    s_nop 0
    buffer_load_dwordx4 v13, s[52:55], s8 offen offset:64 lds
    s_mov_b32 m0, 81792
    s_nop 0
    buffer_load_dwordx4 v13, s[52:55], s8 offen offset:128 lds
    s_waitcnt vmcnt(34)
    v_mov_b32 v24, 16
    ds_write_b32 v2, v24 offset:0
    s_mov_b32 m0, 70656
    s_add_u32 s8, s12, 132096
    buffer_load_dwordx4 v12, s[48:51], s8 offen offset:0 lds
    s_mov_b32 m0, 71616
    s_mul_i32 s12, s10, 176128
    buffer_load_dwordx4 v12, s[48:51], s8 offen offset:64 lds
    s_mov_b32 m0, 72576
    s_add_u32 s12, s12, s7
    buffer_load_dwordx4 v12, s[48:51], s8 offen offset:128 lds
    s_mov_b32 m0, 82944
    s_waitcnt lgkmcnt(1)
    v_min3_u32 v20, v20, v21, v22
    v_min_u32 v20, v20, v23
    buffer_load_dwordx4 v13, s[52:55], s8 offen offset:0 lds
    s_mov_b32 m0, 83904
    s_nop 0
    buffer_load_dwordx4 v13, s[52:55], s8 offen offset:64 lds
    s_mov_b32 m0, 84864
    v_readfirstlane_b32 s13, v20
    buffer_load_dwordx4 v13, s[52:55], s8 offen offset:128 lds
    s_add_u32 s14, s9, 540672
    buffer_load_dwordx4 v[32:35], v16, s[56:59], s14 offen
    s_add_u32 s14, s9, 548864
    buffer_load_dwordx4 v[36:39], v16, s[56:59], s14 offen
    s_add_u32 s14, s9, 557056
    buffer_load_dwordx4 v[40:43], v16, s[56:59], s14 offen
    s_add_u32 s14, s9, 565248
    buffer_load_dwordx4 v[44:47], v16, s[56:59], s14 offen
    s_add_u32 s14, s9, 573440
    buffer_load_dwordx4 v[48:51], v16, s[56:59], s14 offen
    s_add_u32 s14, s9, 581632
    buffer_load_dwordx4 v[52:55], v16, s[56:59], s14 offen
    s_add_u32 s14, s9, 589824
    buffer_load_dwordx4 v[56:59], v16, s[56:59], s14 offen
    s_add_u32 s14, s9, 598016
    buffer_load_dwordx4 v[60:63], v16, s[56:59], s14 offen
    s_add_u32 s14, s9, 606208
    buffer_load_dwordx4 v[64:67], v16, s[56:59], s14 offen
    s_cmp_lt_u32 s13, 3
    s_cbranch_scc1 Lbs9
Lbr10:
    s_mov_b32 m0, 90112
    s_add_u32 s8, s11, 0
    buffer_load_dwordx4 v8, s[44:47], s8 offen offset:0 lds
    buffer_load_dwordx4 v9, s[44:47], s8 offen offset:1024 lds
    buffer_load_dwordx4 v10, s[44:47], s8 offen offset:2048 lds
    buffer_load_dwordx4 v11, s[44:47], s8 offen offset:3072 lds
    s_mov_b32 m0, 94208
    s_add_u32 s8, s11, 32768
    buffer_load_dwordx4 v8, s[44:47], s8 offen offset:0 lds
    buffer_load_dwordx4 v9, s[44:47], s8 offen offset:1024 lds
    buffer_load_dwordx4 v10, s[44:47], s8 offen offset:2048 lds
    buffer_load_dwordx4 v11, s[44:47], s8 offen offset:3072 lds
    s_mov_b32 m0, 98304
    s_add_u32 s8, s11, 65536
    buffer_load_dwordx4 v8, s[44:47], s8 offen offset:0 lds
    buffer_load_dwordx4 v9, s[44:47], s8 offen offset:1024 lds
    buffer_load_dwordx4 v10, s[44:47], s8 offen offset:2048 lds
    buffer_load_dwordx4 v11, s[44:47], s8 offen offset:3072 lds
    s_waitcnt vmcnt(33)
    v_mov_b32 v24, 18
    ds_write_b32 v2, v24 offset:0
    s_mov_b32 m0, 102400
    s_add_u32 s8, s11, 98304
    buffer_load_dwordx4 v8, s[44:47], s8 offen offset:0 lds
    buffer_load_dwordx4 v9, s[44:47], s8 offen offset:1024 lds
    buffer_load_dwordx4 v10, s[44:47], s8 offen offset:2048 lds
    buffer_load_dwordx4 v11, s[44:47], s8 offen offset:3072 lds
    s_mov_b32 m0, 106496
    s_add_u32 s8, s12, 0
    buffer_load_dwordx4 v12, s[48:51], s8 offen offset:0 lds
    s_mov_b32 m0, 107456
    s_add_u32 s10, s10, 1
    buffer_load_dwordx4 v12, s[48:51], s8 offen offset:64 lds
    s_mov_b32 m0, 108416
    s_and_b32 s10, s10, 7
    buffer_load_dwordx4 v12, s[48:51], s8 offen offset:128 lds
    s_mov_b32 m0, 118784
    s_lshl_b32 s11, s10, 7
    buffer_load_dwordx4 v13, s[52:55], s8 offen offset:0 lds
    s_mov_b32 m0, 119744
    s_add_u32 s11, s11, s6
    buffer_load_dwordx4 v13, s[52:55], s8 offen offset:64 lds
    s_mov_b32 m0, 120704
    s_nop 0
    buffer_load_dwordx4 v13, s[52:55], s8 offen offset:128 lds
    s_waitcnt vmcnt(31)
    v_mov_b32 v24, 20
    ds_write_b32 v2, v24 offset:0
    s_mov_b32 m0, 109568
    s_add_u32 s8, s12, 44032
    buffer_load_dwordx4 v12, s[48:51], s8 offen offset:0 lds
    s_mov_b32 m0, 110528
    s_nop 0
    buffer_load_dwordx4 v12, s[48:51], s8 offen offset:64 lds
    s_mov_b32 m0, 111488
    s_nop 0
    buffer_load_dwordx4 v12, s[48:51], s8 offen offset:128 lds
    s_mov_b32 m0, 121856
    s_nop 0
    buffer_load_dwordx4 v13, s[52:55], s8 offen offset:0 lds
    s_mov_b32 m0, 122816
    s_nop 0
    buffer_load_dwordx4 v13, s[52:55], s8 offen offset:64 lds
    s_mov_b32 m0, 123776
    s_nop 0
    buffer_load_dwordx4 v13, s[52:55], s8 offen offset:128 lds
    s_mov_b32 m0, 112640
    s_add_u32 s8, s12, 88064
    buffer_load_dwordx4 v12, s[48:51], s8 offen offset:0 lds
    s_mov_b32 m0, 113600
    ds_read_b128 v[20:23], v2 offset:16
    buffer_load_dwordx4 v12, s[48:51], s8 offen offset:64 lds
    s_mov_b32 m0, 114560
    s_nop 0
    buffer_load_dwordx4 v12, s[48:51], s8 offen offset:128 lds
    s_mov_b32 m0, 124928
    s_nop 0
    buffer_load_dwordx4 v13, s[52:55], s8 offen offset:0 lds
    s_mov_b32 m0, 125888
    s_nop 0
    buffer_load_dwordx4 v13, s[52:55], s8 offen offset:64 lds
    s_mov_b32 m0, 126848
    s_nop 0
    buffer_load_dwordx4 v13, s[52:55], s8 offen offset:128 lds
    s_mov_b32 m0, 115712
    s_add_u32 s8, s12, 132096
    buffer_load_dwordx4 v12, s[48:51], s8 offen offset:0 lds
    s_mov_b32 m0, 116672
    s_mul_i32 s12, s10, 176128
    buffer_load_dwordx4 v12, s[48:51], s8 offen offset:64 lds
    s_mov_b32 m0, 117632
    s_add_u32 s12, s12, s7
    buffer_load_dwordx4 v12, s[48:51], s8 offen offset:128 lds
    s_mov_b32 m0, 128000
    s_waitcnt lgkmcnt(0)
    v_min3_u32 v20, v20, v21, v22
    v_min_u32 v20, v20, v23
    buffer_load_dwordx4 v13, s[52:55], s8 offen offset:0 lds
    s_mov_b32 m0, 128960
    s_nop 0
    buffer_load_dwordx4 v13, s[52:55], s8 offen offset:64 lds
    s_mov_b32 m0, 129920
    v_readfirstlane_b32 s13, v20
    buffer_load_dwordx4 v13, s[52:55], s8 offen offset:128 lds
    s_add_u32 s14, s9, 614400
    buffer_load_dwordx4 v[68:71], v16, s[56:59], s14 offen
    s_add_u32 s14, s9, 622592
    buffer_load_dwordx4 v[72:75], v16, s[56:59], s14 offen
    s_add_u32 s14, s9, 630784
    buffer_load_dwordx4 v[76:79], v16, s[56:59], s14 offen
    s_add_u32 s14, s9, 638976
    buffer_load_dwordx4 v[80:83], v16, s[56:59], s14 offen
    s_add_u32 s14, s9, 647168
    buffer_load_dwordx4 v[84:87], v16, s[56:59], s14 offen
    s_add_u32 s14, s9, 655360
    buffer_load_dwordx4 v[88:91], v16, s[56:59], s14 offen
    s_add_u32 s14, s9, 663552
    buffer_load_dwordx4 v[92:95], v16, s[56:59], s14 offen
    s_add_u32 s14, s9, 671744
    buffer_load_dwordx4 v[96:99], v16, s[56:59], s14 offen
    s_add_u32 s14, s9, 679936
    buffer_load_dwordx4 v[100:103], v16, s[56:59], s14 offen
    s_cmp_lt_u32 s13, 4
    s_cbranch_scc1 Lbs13
Lbr14:
    s_mov_b32 m0, 0
    s_add_u32 s8, s11, 0
    buffer_load_dwordx4 v8, s[44:47], s8 offen offset:0 lds
    buffer_load_dwordx4 v9, s[44:47], s8 offen offset:1024 lds
    buffer_load_dwordx4 v10, s[44:47], s8 offen offset:2048 lds
    buffer_load_dwordx4 v11, s[44:47], s8 offen offset:3072 lds
    s_mov_b32 m0, 4096
    s_add_u32 s8, s11, 32768
    buffer_load_dwordx4 v8, s[44:47], s8 offen offset:0 lds
    buffer_load_dwordx4 v9, s[44:47], s8 offen offset:1024 lds
    buffer_load_dwordx4 v10, s[44:47], s8 offen offset:2048 lds
    buffer_load_dwordx4 v11, s[44:47], s8 offen offset:3072 lds
    s_mov_b32 m0, 8192
    s_add_u32 s8, s11, 65536
    buffer_load_dwordx4 v8, s[44:47], s8 offen offset:0 lds
    buffer_load_dwordx4 v9, s[44:47], s8 offen offset:1024 lds
    buffer_load_dwordx4 v10, s[44:47], s8 offen offset:2048 lds
    buffer_load_dwordx4 v11, s[44:47], s8 offen offset:3072 lds
    s_waitcnt vmcnt(33)
    v_mov_b32 v24, 22
    ds_write_b32 v2, v24 offset:0
    s_mov_b32 m0, 12288
    s_add_u32 s8, s11, 98304
    buffer_load_dwordx4 v8, s[44:47], s8 offen offset:0 lds
    buffer_load_dwordx4 v9, s[44:47], s8 offen offset:1024 lds
    buffer_load_dwordx4 v10, s[44:47], s8 offen offset:2048 lds
    buffer_load_dwordx4 v11, s[44:47], s8 offen offset:3072 lds
    s_mov_b32 m0, 16384
    s_add_u32 s8, s12, 0
    buffer_load_dwordx4 v12, s[48:51], s8 offen offset:0 lds
    s_mov_b32 m0, 17344
    s_add_u32 s10, s10, 1
    buffer_load_dwordx4 v12, s[48:51], s8 offen offset:64 lds
    s_mov_b32 m0, 18304
    s_and_b32 s10, s10, 7
    buffer_load_dwordx4 v12, s[48:51], s8 offen offset:128 lds
    s_mov_b32 m0, 28672
    s_lshl_b32 s11, s10, 7
    buffer_load_dwordx4 v13, s[52:55], s8 offen offset:0 lds
    s_mov_b32 m0, 29632
    s_add_u32 s11, s11, s6
    buffer_load_dwordx4 v13, s[52:55], s8 offen offset:64 lds
    s_mov_b32 m0, 30592
    s_nop 0
    buffer_load_dwordx4 v13, s[52:55], s8 offen offset:128 lds
    s_waitcnt vmcnt(31)
    v_mov_b32 v24, 24
    ds_write_b32 v2, v24 offset:0
    s_mov_b32 m0, 19456
    s_add_u32 s8, s12, 44032
    buffer_load_dwordx4 v12, s[48:51], s8 offen offset:0 lds
    s_mov_b32 m0, 20416
    s_nop 0
    buffer_load_dwordx4 v12, s[48:51], s8 offen offset:64 lds
    s_mov_b32 m0, 21376
    s_nop 0
    buffer_load_dwordx4 v12, s[48:51], s8 offen offset:128 lds
    s_mov_b32 m0, 31744
    s_nop 0
    buffer_load_dwordx4 v13, s[52:55], s8 offen offset:0 lds
    s_mov_b32 m0, 32704
    s_nop 0
    buffer_load_dwordx4 v13, s[52:55], s8 offen offset:64 lds
    s_mov_b32 m0, 33664
    s_nop 0
    buffer_load_dwordx4 v13, s[52:55], s8 offen offset:128 lds
    s_mov_b32 m0, 22528
    s_add_u32 s8, s12, 88064
    buffer_load_dwordx4 v12, s[48:51], s8 offen offset:0 lds
    s_mov_b32 m0, 23488
    ds_read_b128 v[20:23], v2 offset:16
    buffer_load_dwordx4 v12, s[48:51], s8 offen offset:64 lds
    s_mov_b32 m0, 24448
    s_nop 0
    buffer_load_dwordx4 v12, s[48:51], s8 offen offset:128 lds
    s_mov_b32 m0, 34816
    s_nop 0
    buffer_load_dwordx4 v13, s[52:55], s8 offen offset:0 lds
    s_mov_b32 m0, 35776
    s_nop 0
    buffer_load_dwordx4 v13, s[52:55], s8 offen offset:64 lds
    s_mov_b32 m0, 36736
    s_nop 0
    buffer_load_dwordx4 v13, s[52:55], s8 offen offset:128 lds
    s_mov_b32 m0, 25600
    s_add_u32 s8, s12, 132096
    buffer_load_dwordx4 v12, s[48:51], s8 offen offset:0 lds
    s_mov_b32 m0, 26560
    s_mul_i32 s12, s10, 176128
    buffer_load_dwordx4 v12, s[48:51], s8 offen offset:64 lds
    s_mov_b32 m0, 27520
    s_add_u32 s12, s12, s7
    buffer_load_dwordx4 v12, s[48:51], s8 offen offset:128 lds
    s_mov_b32 m0, 37888
    s_waitcnt lgkmcnt(0)
    v_min3_u32 v20, v20, v21, v22
    v_min_u32 v20, v20, v23
    buffer_load_dwordx4 v13, s[52:55], s8 offen offset:0 lds
    s_mov_b32 m0, 38848
    s_nop 0
    buffer_load_dwordx4 v13, s[52:55], s8 offen offset:64 lds
    s_mov_b32 m0, 39808
    v_readfirstlane_b32 s13, v20
    buffer_load_dwordx4 v13, s[52:55], s8 offen offset:128 lds
    s_add_u32 s14, s9, 688128
    buffer_load_dwordx4 v[104:107], v16, s[56:59], s14 offen
    s_add_u32 s14, s9, 696320
    buffer_load_dwordx4 v[108:111], v16, s[56:59], s14 offen
    s_add_u32 s14, s9, 704512
    buffer_load_dwordx4 v[112:115], v16, s[56:59], s14 offen
    s_add_u32 s14, s9, 712704
    buffer_load_dwordx4 v[116:119], v16, s[56:59], s14 offen
    s_add_u32 s14, s9, 1261568
    buffer_load_dwordx4 v[120:123], v16, s[56:59], s14 offen
    s_add_u32 s14, s9, 1269760
    buffer_load_dwordx4 v[124:127], v16, s[56:59], s14 offen
    s_add_u32 s14, s9, 1277952
    buffer_load_dwordx4 v[128:131], v16, s[56:59], s14 offen
    s_add_u32 s14, s9, 1286144
    buffer_load_dwordx4 v[132:135], v16, s[56:59], s14 offen
    s_add_u32 s14, s9, 1294336
    buffer_load_dwordx4 v[136:139], v16, s[56:59], s14 offen
    s_cmp_lt_u32 s13, 5
    s_cbranch_scc1 Lbs17
Lbr18:
    s_mov_b32 m0, 45056
    s_add_u32 s8, s11, 0
    buffer_load_dwordx4 v8, s[44:47], s8 offen offset:0 lds
    buffer_load_dwordx4 v9, s[44:47], s8 offen offset:1024 lds
    buffer_load_dwordx4 v10, s[44:47], s8 offen offset:2048 lds
    buffer_load_dwordx4 v11, s[44:47], s8 offen offset:3072 lds
    s_mov_b32 m0, 49152
    s_add_u32 s8, s11, 32768
    buffer_load_dwordx4 v8, s[44:47], s8 offen offset:0 lds
    buffer_load_dwordx4 v9, s[44:47], s8 offen offset:1024 lds
    buffer_load_dwordx4 v10, s[44:47], s8 offen offset:2048 lds
    buffer_load_dwordx4 v11, s[44:47], s8 offen offset:3072 lds
    s_mov_b32 m0, 53248
    s_add_u32 s8, s11, 65536
    buffer_load_dwordx4 v8, s[44:47], s8 offen offset:0 lds
    buffer_load_dwordx4 v9, s[44:47], s8 offen offset:1024 lds
    buffer_load_dwordx4 v10, s[44:47], s8 offen offset:2048 lds
    buffer_load_dwordx4 v11, s[44:47], s8 offen offset:3072 lds
    s_waitcnt vmcnt(33)
    v_mov_b32 v24, 26
    ds_write_b32 v2, v24 offset:0
    s_mov_b32 m0, 57344
    s_add_u32 s8, s11, 98304
    buffer_load_dwordx4 v8, s[44:47], s8 offen offset:0 lds
    buffer_load_dwordx4 v9, s[44:47], s8 offen offset:1024 lds
    buffer_load_dwordx4 v10, s[44:47], s8 offen offset:2048 lds
    buffer_load_dwordx4 v11, s[44:47], s8 offen offset:3072 lds
    s_mov_b32 m0, 61440
    s_add_u32 s8, s12, 0
    buffer_load_dwordx4 v12, s[48:51], s8 offen offset:0 lds
    s_mov_b32 m0, 62400
    s_add_u32 s10, s10, 1
    buffer_load_dwordx4 v12, s[48:51], s8 offen offset:64 lds
    s_mov_b32 m0, 63360
    s_and_b32 s10, s10, 7
    buffer_load_dwordx4 v12, s[48:51], s8 offen offset:128 lds
    s_mov_b32 m0, 73728
    s_lshl_b32 s11, s10, 7
    buffer_load_dwordx4 v13, s[52:55], s8 offen offset:0 lds
    s_mov_b32 m0, 74688
    s_add_u32 s11, s11, s6
    buffer_load_dwordx4 v13, s[52:55], s8 offen offset:64 lds
    s_mov_b32 m0, 75648
    s_nop 0
    buffer_load_dwordx4 v13, s[52:55], s8 offen offset:128 lds
    s_waitcnt vmcnt(31)
    v_mov_b32 v24, 28
    ds_write_b32 v2, v24 offset:0
    s_mov_b32 m0, 64512
    s_add_u32 s8, s12, 44032
    buffer_load_dwordx4 v12, s[48:51], s8 offen offset:0 lds
    s_mov_b32 m0, 65472
    s_nop 0
    buffer_load_dwordx4 v12, s[48:51], s8 offen offset:64 lds
    s_mov_b32 m0, 66432
    s_nop 0
    buffer_load_dwordx4 v12, s[48:51], s8 offen offset:128 lds
    s_mov_b32 m0, 76800
    s_nop 0
    buffer_load_dwordx4 v13, s[52:55], s8 offen offset:0 lds
    s_mov_b32 m0, 77760
    s_nop 0
    buffer_load_dwordx4 v13, s[52:55], s8 offen offset:64 lds
    s_mov_b32 m0, 78720
    s_nop 0
    buffer_load_dwordx4 v13, s[52:55], s8 offen offset:128 lds
    s_mov_b32 m0, 67584
    s_add_u32 s8, s12, 88064
    buffer_load_dwordx4 v12, s[48:51], s8 offen offset:0 lds
    s_mov_b32 m0, 68544
    s_nop 0
    buffer_load_dwordx4 v12, s[48:51], s8 offen offset:64 lds
    s_mov_b32 m0, 69504
    s_nop 0
    buffer_load_dwordx4 v12, s[48:51], s8 offen offset:128 lds
    s_mov_b32 m0, 79872
    s_nop 0
    buffer_load_dwordx4 v13, s[52:55], s8 offen offset:0 lds
    s_mov_b32 m0, 80832
    s_nop 0
    buffer_load_dwordx4 v13, s[52:55], s8 offen offset:64 lds
    s_mov_b32 m0, 81792
    s_nop 0
    buffer_load_dwordx4 v13, s[52:55], s8 offen offset:128 lds
    s_mov_b32 m0, 70656
    s_add_u32 s8, s12, 132096
    buffer_load_dwordx4 v12, s[48:51], s8 offen offset:0 lds
    s_mov_b32 m0, 71616
    s_mul_i32 s12, s10, 176128
    buffer_load_dwordx4 v12, s[48:51], s8 offen offset:64 lds
    s_mov_b32 m0, 72576
    s_add_u32 s12, s12, s7
    buffer_load_dwordx4 v12, s[48:51], s8 offen offset:128 lds
    s_mov_b32 m0, 82944
    s_nop 0
    buffer_load_dwordx4 v13, s[52:55], s8 offen offset:0 lds
    s_mov_b32 m0, 83904
    s_nop 0
    buffer_load_dwordx4 v13, s[52:55], s8 offen offset:64 lds
    s_mov_b32 m0, 84864
    s_nop 0
    buffer_load_dwordx4 v13, s[52:55], s8 offen offset:128 lds
    v_mov_b32 v25, 1
    ds_write_b32 v2, v25 offset:88
    s_add_u32 s14, s9, 1302528
    buffer_load_dwordx4 v[140:143], v16, s[56:59], s14 offen
    s_add_u32 s14, s9, 1310720
    buffer_load_dwordx4 v[144:147], v16, s[56:59], s14 offen
    s_add_u32 s14, s9, 1318912
    buffer_load_dwordx4 v[148:151], v16, s[56:59], s14 offen
    s_add_u32 s14, s9, 1327104
    buffer_load_dwordx4 v[152:155], v16, s[56:59], s14 offen
    s_add_u32 s14, s9, 1335296
    buffer_load_dwordx4 v[156:159], v16, s[56:59], s14 offen
    s_add_u32 s14, s9, 1343488
    buffer_load_dwordx4 v[160:163], v16, s[56:59], s14 offen
    s_add_u32 s14, s9, 1351680
    buffer_load_dwordx4 v[164:167], v16, s[56:59], s14 offen
    s_waitcnt vmcnt(19)
    v_mov_b32 v24, 30
    ds_write_b32 v2, v24 offset:0
    s_waitcnt vmcnt(7)
    v_mov_b32 v24, 32
    ds_write_b32 v2, v24 offset:0
L_Bwd:
    s_setprio 1
    v_lshlrev_b32 v26, 7, v1
    s_mul_i32 s11, s70, 3
    s_add_u32 s11, s11, 0
    s_min_u32 s11, s11, 87
    s_add_u32 s12, s11, 44
    s_cmp_lt_u32 s11, 44
    s_cselect_b32 s11, s11, s12
    s_lshl_b32 s11, s11, 13
    s_add_u32 s11, s11, 180224
    buffer_load_dword v28, v26, s[56:59], s11 offen
    s_mul_i32 s11, s70, 3
    s_add_u32 s11, s11, 1
    s_min_u32 s11, s11, 87
    s_add_u32 s12, s11, 44
    s_cmp_lt_u32 s11, 44
    s_cselect_b32 s11, s11, s12
    s_lshl_b32 s11, s11, 13
    s_add_u32 s11, s11, 180224
    buffer_load_dword v28, v26, s[56:59], s11 offen
    s_mul_i32 s11, s70, 3
    s_add_u32 s11, s11, 2
    s_min_u32 s11, s11, 87
    s_add_u32 s12, s11, 44
    s_cmp_lt_u32 s11, 44
    s_cselect_b32 s11, s11, s12
    s_lshl_b32 s11, s11, 13
    s_add_u32 s11, s11, 180224
    buffer_load_dword v28, v26, s[56:59], s11 offen
    s_mov_b32 s5, 0x8000
Lp21:
    ds_read_b128 v[20:23], v2 offset:16
    s_waitcnt lgkmcnt(0)
    v_min3_u32 v20, v20, v21, v22
    v_min_u32 v20, v20, v23
    s_nop 0
    v_readfirstlane_b32 s4, v20
    s_nop 0
    s_cmp_ge_u32 s4, 6
    s_cbranch_scc1 Lpe22
    s_sleep 1
    s_sub_u32 s5, s5, 1
    s_cmp_lg_u32 s5, 0
    s_cbranch_scc1 Lp21
Lpe22:
    s_mov_b32 m0, 90112
    s_add_u32 s8, s9, 0
    buffer_load_dwordx4 v16, s[56:59], s8 offen offset:0 lds
    buffer_load_dwordx4 v17, s[56:59], s8 offen offset:1024 lds
    buffer_load_dwordx4 v18, s[56:59], s8 offen offset:2048 lds
    buffer_load_dwordx4 v19, s[56:59], s8 offen offset:3072 lds
    s_mov_b32 m0, 94208
    s_add_u32 s8, s9, 32768
    buffer_load_dwordx4 v16, s[56:59], s8 offen offset:0 lds
    buffer_load_dwordx4 v17, s[56:59], s8 offen offset:1024 lds
    buffer_load_dwordx4 v18, s[56:59], s8 offen offset:2048 lds
    buffer_load_dwordx4 v19, s[56:59], s8 offen offset:3072 lds
    s_mov_b32 m0, 98304
    s_add_u32 s8, s9, 65536
    buffer_load_dwordx4 v16, s[56:59], s8 offen offset:0 lds
    buffer_load_dwordx4 v17, s[56:59], s8 offen offset:1024 lds
    buffer_load_dwordx4 v18, s[56:59], s8 offen offset:2048 lds
    buffer_load_dwordx4 v19, s[56:59], s8 offen offset:3072 lds
    s_mov_b32 m0, 102400
    s_add_u32 s8, s9, 98304
    buffer_load_dwordx4 v16, s[56:59], s8 offen offset:0 lds
    buffer_load_dwordx4 v17, s[56:59], s8 offen offset:1024 lds
    buffer_load_dwordx4 v18, s[56:59], s8 offen offset:2048 lds
    buffer_load_dwordx4 v19, s[56:59], s8 offen offset:3072 lds
    s_mov_b32 m0, 106496
    s_add_u32 s8, s9, 131072
    buffer_load_dwordx4 v16, s[56:59], s8 offen offset:0 lds
    buffer_load_dwordx4 v17, s[56:59], s8 offen offset:1024 lds
    buffer_load_dwordx4 v18, s[56:59], s8 offen offset:2048 lds
    buffer_load_dwordx4 v19, s[56:59], s8 offen offset:3072 lds
    s_mov_b32 m0, 110592
    s_add_u32 s8, s9, 163840
    buffer_load_dwordx4 v16, s[56:59], s8 offen offset:0 lds
    buffer_load_dwordx4 v17, s[56:59], s8 offen offset:1024 lds
    s_mov_b32 m0, 112640
    s_add_u32 s8, s9, 720896
    buffer_load_dwordx4 v16, s[56:59], s8 offen offset:0 lds
    buffer_load_dwordx4 v17, s[56:59], s8 offen offset:1024 lds
    buffer_load_dwordx4 v18, s[56:59], s8 offen offset:2048 lds
    buffer_load_dwordx4 v19, s[56:59], s8 offen offset:3072 lds
    s_mov_b32 m0, 116736
    s_add_u32 s8, s9, 753664
    buffer_load_dwordx4 v16, s[56:59], s8 offen offset:0 lds
    buffer_load_dwordx4 v17, s[56:59], s8 offen offset:1024 lds
    buffer_load_dwordx4 v18, s[56:59], s8 offen offset:2048 lds
    buffer_load_dwordx4 v19, s[56:59], s8 offen offset:3072 lds
    s_mov_b32 m0, 120832
    s_add_u32 s8, s9, 786432
    buffer_load_dwordx4 v16, s[56:59], s8 offen offset:0 lds
    buffer_load_dwordx4 v17, s[56:59], s8 offen offset:1024 lds
    buffer_load_dwordx4 v18, s[56:59], s8 offen offset:2048 lds
    buffer_load_dwordx4 v19, s[56:59], s8 offen offset:3072 lds
    s_waitcnt vmcnt(40)
    s_mov_b32 m0, 124928
    s_add_u32 s8, s9, 819200
    buffer_load_dwordx4 v16, s[56:59], s8 offen offset:0 lds
    buffer_load_dwordx4 v17, s[56:59], s8 offen offset:1024 lds
    buffer_load_dwordx4 v18, s[56:59], s8 offen offset:2048 lds
    buffer_load_dwordx4 v19, s[56:59], s8 offen offset:3072 lds
    s_waitcnt vmcnt(40)
    s_mov_b32 m0, 129024
    s_add_u32 s8, s9, 851968
    buffer_load_dwordx4 v16, s[56:59], s8 offen offset:0 lds
    buffer_load_dwordx4 v17, s[56:59], s8 offen offset:1024 lds
    buffer_load_dwordx4 v18, s[56:59], s8 offen offset:2048 lds
    buffer_load_dwordx4 v19, s[56:59], s8 offen offset:3072 lds
    s_waitcnt vmcnt(40)
    s_mov_b32 m0, 133120
    s_add_u32 s8, s9, 884736
    buffer_load_dwordx4 v16, s[56:59], s8 offen offset:0 lds
    buffer_load_dwordx4 v17, s[56:59], s8 offen offset:1024 lds
    s_mov_b32 s5, 0x8000
Lp23:
    ds_read_b128 v[20:23], v2 offset:16
    s_waitcnt lgkmcnt(0)
    v_min3_u32 v20, v20, v21, v22
    v_min_u32 v20, v20, v23
    s_nop 0
    v_readfirstlane_b32 s4, v20
    s_nop 0
    s_cmp_ge_u32 s4, 7
    s_cbranch_scc1 Lpe24
    s_sleep 1
    s_sub_u32 s5, s5, 1
    s_cmp_lg_u32 s5, 0
    s_cbranch_scc1 Lp23
Lpe24:
    s_mov_b32 m0, 0
    s_add_u32 s8, s9, 180224
    buffer_load_dwordx4 v16, s[56:59], s8 offen offset:0 lds
    buffer_load_dwordx4 v17, s[56:59], s8 offen offset:1024 lds
    buffer_load_dwordx4 v18, s[56:59], s8 offen offset:2048 lds
    buffer_load_dwordx4 v19, s[56:59], s8 offen offset:3072 lds
    s_waitcnt vmcnt(40)
    s_mov_b32 m0, 4096
    s_add_u32 s8, s9, 212992
    buffer_load_dwordx4 v16, s[56:59], s8 offen offset:0 lds
    buffer_load_dwordx4 v17, s[56:59], s8 offen offset:1024 lds
    buffer_load_dwordx4 v18, s[56:59], s8 offen offset:2048 lds
    buffer_load_dwordx4 v19, s[56:59], s8 offen offset:3072 lds
    s_waitcnt vmcnt(40)
    s_mov_b32 m0, 8192
    s_add_u32 s8, s9, 245760
    buffer_load_dwordx4 v16, s[56:59], s8 offen offset:0 lds
    buffer_load_dwordx4 v17, s[56:59], s8 offen offset:1024 lds
    buffer_load_dwordx4 v18, s[56:59], s8 offen offset:2048 lds
    buffer_load_dwordx4 v19, s[56:59], s8 offen offset:3072 lds
    s_waitcnt vmcnt(40)
    s_mov_b32 m0, 12288
    s_add_u32 s8, s9, 278528
    buffer_load_dwordx4 v16, s[56:59], s8 offen offset:0 lds
    buffer_load_dwordx4 v17, s[56:59], s8 offen offset:1024 lds
    buffer_load_dwordx4 v18, s[56:59], s8 offen offset:2048 lds
    buffer_load_dwordx4 v19, s[56:59], s8 offen offset:3072 lds
    s_waitcnt vmcnt(40)
    s_mov_b32 m0, 16384
    s_add_u32 s8, s9, 311296
    buffer_load_dwordx4 v16, s[56:59], s8 offen offset:0 lds
    buffer_load_dwordx4 v17, s[56:59], s8 offen offset:1024 lds
    buffer_load_dwordx4 v18, s[56:59], s8 offen offset:2048 lds
    buffer_load_dwordx4 v19, s[56:59], s8 offen offset:3072 lds
    s_waitcnt vmcnt(40)
    s_mov_b32 m0, 20480
    s_add_u32 s8, s9, 344064
    buffer_load_dwordx4 v16, s[56:59], s8 offen offset:0 lds
    buffer_load_dwordx4 v17, s[56:59], s8 offen offset:1024 lds
    s_mov_b32 m0, 22528
    s_add_u32 s8, s9, 901120
    buffer_load_dwordx4 v16, s[56:59], s8 offen offset:0 lds
    buffer_load_dwordx4 v17, s[56:59], s8 offen offset:1024 lds
    buffer_load_dwordx4 v18, s[56:59], s8 offen offset:2048 lds
    buffer_load_dwordx4 v19, s[56:59], s8 offen offset:3072 lds
    s_waitcnt vmcnt(40)
    s_mov_b32 m0, 26624
    s_add_u32 s8, s9, 933888
    buffer_load_dwordx4 v16, s[56:59], s8 offen offset:0 lds
    buffer_load_dwordx4 v17, s[56:59], s8 offen offset:1024 lds
    buffer_load_dwordx4 v18, s[56:59], s8 offen offset:2048 lds
    buffer_load_dwordx4 v19, s[56:59], s8 offen offset:3072 lds
    s_waitcnt vmcnt(40)
    s_mov_b32 m0, 30720
    s_add_u32 s8, s9, 966656
    buffer_load_dwordx4 v16, s[56:59], s8 offen offset:0 lds
    buffer_load_dwordx4 v17, s[56:59], s8 offen offset:1024 lds
    buffer_load_dwordx4 v18, s[56:59], s8 offen offset:2048 lds
    buffer_load_dwordx4 v19, s[56:59], s8 offen offset:3072 lds
    s_waitcnt vmcnt(40)
    s_mov_b32 m0, 34816
    s_add_u32 s8, s9, 999424
    buffer_load_dwordx4 v16, s[56:59], s8 offen offset:0 lds
    buffer_load_dwordx4 v17, s[56:59], s8 offen offset:1024 lds
    buffer_load_dwordx4 v18, s[56:59], s8 offen offset:2048 lds
    buffer_load_dwordx4 v19, s[56:59], s8 offen offset:3072 lds
    s_waitcnt vmcnt(40)
    s_mov_b32 m0, 38912
    s_add_u32 s8, s9, 1032192
    buffer_load_dwordx4 v16, s[56:59], s8 offen offset:0 lds
    buffer_load_dwordx4 v17, s[56:59], s8 offen offset:1024 lds
    buffer_load_dwordx4 v18, s[56:59], s8 offen offset:2048 lds
    buffer_load_dwordx4 v19, s[56:59], s8 offen offset:3072 lds
    s_waitcnt vmcnt(40)
    v_mov_b32 v24, 33
    ds_write_b32 v2, v24 offset:0
    s_mov_b32 m0, 43008
    s_add_u32 s8, s9, 1064960
    buffer_load_dwordx4 v16, s[56:59], s8 offen offset:0 lds
    buffer_load_dwordx4 v17, s[56:59], s8 offen offset:1024 lds
    s_mov_b32 s5, 0x8000
Lp25:
    ds_read_b128 v[20:23], v2 offset:16
    s_waitcnt lgkmcnt(0)
    v_min3_u32 v20, v20, v21, v22
    v_min_u32 v20, v20, v23
    s_nop 0
    v_readfirstlane_b32 s4, v20
    s_nop 0
    s_cmp_ge_u32 s4, 8
    s_cbranch_scc1 Lpe26
    s_sleep 1
    s_sub_u32 s5, s5, 1
    s_cmp_lg_u32 s5, 0
    s_cbranch_scc1 Lp25
Lpe26:
    s_mov_b32 m0, 45056
    s_add_u32 s8, s9, 360448
    buffer_load_dwordx4 v16, s[56:59], s8 offen offset:0 lds
    buffer_load_dwordx4 v17, s[56:59], s8 offen offset:1024 lds
    buffer_load_dwordx4 v18, s[56:59], s8 offen offset:2048 lds
    buffer_load_dwordx4 v19, s[56:59], s8 offen offset:3072 lds
    s_waitcnt vmcnt(40)
    s_mov_b32 m0, 49152
    s_add_u32 s8, s9, 393216
    buffer_load_dwordx4 v16, s[56:59], s8 offen offset:0 lds
    buffer_load_dwordx4 v17, s[56:59], s8 offen offset:1024 lds
    buffer_load_dwordx4 v18, s[56:59], s8 offen offset:2048 lds
    buffer_load_dwordx4 v19, s[56:59], s8 offen offset:3072 lds
    s_waitcnt vmcnt(40)
    s_mov_b32 m0, 53248
    s_add_u32 s8, s9, 425984
    buffer_load_dwordx4 v16, s[56:59], s8 offen offset:0 lds
    buffer_load_dwordx4 v17, s[56:59], s8 offen offset:1024 lds
    buffer_load_dwordx4 v18, s[56:59], s8 offen offset:2048 lds
    buffer_load_dwordx4 v19, s[56:59], s8 offen offset:3072 lds
    s_waitcnt vmcnt(40)
    s_mov_b32 m0, 57344
    s_add_u32 s8, s9, 458752
    buffer_load_dwordx4 v16, s[56:59], s8 offen offset:0 lds
    buffer_load_dwordx4 v17, s[56:59], s8 offen offset:1024 lds
    buffer_load_dwordx4 v18, s[56:59], s8 offen offset:2048 lds
    buffer_load_dwordx4 v19, s[56:59], s8 offen offset:3072 lds
    s_waitcnt vmcnt(40)
    s_mov_b32 m0, 61440
    s_add_u32 s8, s9, 491520
    buffer_load_dwordx4 v16, s[56:59], s8 offen offset:0 lds
    buffer_load_dwordx4 v17, s[56:59], s8 offen offset:1024 lds
    buffer_load_dwordx4 v18, s[56:59], s8 offen offset:2048 lds
    buffer_load_dwordx4 v19, s[56:59], s8 offen offset:3072 lds
    s_waitcnt vmcnt(40)
    s_mov_b32 m0, 65536
    s_add_u32 s8, s9, 524288
    buffer_load_dwordx4 v16, s[56:59], s8 offen offset:0 lds
    buffer_load_dwordx4 v17, s[56:59], s8 offen offset:1024 lds
    s_mov_b32 m0, 67584
    s_add_u32 s8, s9, 1081344
    buffer_load_dwordx4 v16, s[56:59], s8 offen offset:0 lds
    buffer_load_dwordx4 v17, s[56:59], s8 offen offset:1024 lds
    buffer_load_dwordx4 v18, s[56:59], s8 offen offset:2048 lds
    buffer_load_dwordx4 v19, s[56:59], s8 offen offset:3072 lds
    s_waitcnt vmcnt(40)
    s_mov_b32 m0, 71680
    s_add_u32 s8, s9, 1114112
    buffer_load_dwordx4 v16, s[56:59], s8 offen offset:0 lds
    buffer_load_dwordx4 v17, s[56:59], s8 offen offset:1024 lds
    buffer_load_dwordx4 v18, s[56:59], s8 offen offset:2048 lds
    buffer_load_dwordx4 v19, s[56:59], s8 offen offset:3072 lds
    s_waitcnt vmcnt(40)
    s_mov_b32 m0, 75776
    s_add_u32 s8, s9, 1146880
    buffer_load_dwordx4 v16, s[56:59], s8 offen offset:0 lds
    buffer_load_dwordx4 v17, s[56:59], s8 offen offset:1024 lds
    buffer_load_dwordx4 v18, s[56:59], s8 offen offset:2048 lds
    buffer_load_dwordx4 v19, s[56:59], s8 offen offset:3072 lds
    s_waitcnt vmcnt(40)
    s_mov_b32 m0, 79872
    s_add_u32 s8, s9, 1179648
    buffer_load_dwordx4 v16, s[56:59], s8 offen offset:0 lds
    buffer_load_dwordx4 v17, s[56:59], s8 offen offset:1024 lds
    buffer_load_dwordx4 v18, s[56:59], s8 offen offset:2048 lds
    buffer_load_dwordx4 v19, s[56:59], s8 offen offset:3072 lds
    s_waitcnt vmcnt(40)
    s_mov_b32 m0, 83968
    s_add_u32 s8, s9, 1212416
    buffer_load_dwordx4 v16, s[56:59], s8 offen offset:0 lds
    buffer_load_dwordx4 v17, s[56:59], s8 offen offset:1024 lds
    buffer_load_dwordx4 v18, s[56:59], s8 offen offset:2048 lds
    buffer_load_dwordx4 v19, s[56:59], s8 offen offset:3072 lds
    s_waitcnt vmcnt(40)
    v_mov_b32 v24, 34
    ds_write_b32 v2, v24 offset:0
    s_mov_b32 m0, 88064
    s_add_u32 s8, s9, 1245184
    buffer_load_dwordx4 v16, s[56:59], s8 offen offset:0 lds
    buffer_load_dwordx4 v17, s[56:59], s8 offen offset:1024 lds
    v_add_u32 v26, 90112, v5
    s_waitcnt vmcnt(0)
    v_mov_b32 v24, 35
    ds_write_b32 v2, v24 offset:0
    s_mov_b32 s5, 0x8000
Lp27:
    ds_read_b128 v[20:23], v2 offset:16
    s_waitcnt lgkmcnt(0)
    v_min3_u32 v20, v20, v21, v22
    v_min_u32 v20, v20, v23
    s_nop 0
    v_readfirstlane_b32 s4, v20
    s_nop 0
    s_cmp_ge_u32 s4, 10
    s_cbranch_scc1 Lpe28
    s_sleep 1
    s_sub_u32 s5, s5, 1
    s_cmp_lg_u32 s5, 0
    s_cbranch_scc1 Lp27
Lpe28:
    s_mov_b32 m0, 124928
    s_add_u32 s8, s9, 1359872
    buffer_load_dwordx4 v16, s[56:59], s8 offen offset:0 lds
    buffer_load_dwordx4 v17, s[56:59], s8 offen offset:1024 lds
    buffer_load_dwordx4 v18, s[56:59], s8 offen offset:2048 lds
    buffer_load_dwordx4 v19, s[56:59], s8 offen offset:3072 lds
    s_mov_b32 m0, 129024
    s_add_u32 s8, s9, 1392640
    buffer_load_dwordx4 v16, s[56:59], s8 offen offset:0 lds
    buffer_load_dwordx4 v17, s[56:59], s8 offen offset:1024 lds
    buffer_load_dwordx4 v18, s[56:59], s8 offen offset:2048 lds
    buffer_load_dwordx4 v19, s[56:59], s8 offen offset:3072 lds
    s_mov_b32 m0, 133120
    s_add_u32 s8, s9, 1425408
    buffer_load_dwordx4 v16, s[56:59], s8 offen offset:0 lds
    buffer_load_dwordx4 v17, s[56:59], s8 offen offset:1024 lds
    ds_write_b128 v26, v[32:35] offset:0
    ds_write_b128 v26, v[36:39] offset:1024
    ds_write_b128 v26, v[40:43] offset:2048
    ds_write_b128 v26, v[44:47] offset:3072
    ds_write_b128 v26, v[48:51] offset:4096
    ds_write_b128 v26, v[52:55] offset:5120
    ds_write_b128 v26, v[56:59] offset:6144
    ds_write_b128 v26, v[60:63] offset:7168
    ds_write_b128 v26, v[64:67] offset:8192
    ds_write_b128 v26, v[68:71] offset:9216
    ds_write_b128 v26, v[72:75] offset:10240
    ds_write_b128 v26, v[76:79] offset:11264
    ds_write_b128 v26, v[80:83] offset:12288
    ds_write_b128 v26, v[84:87] offset:13312
    ds_write_b128 v26, v[88:91] offset:14336
    ds_write_b128 v26, v[92:95] offset:15360
    ds_write_b128 v26, v[96:99] offset:16384
    ds_write_b128 v26, v[100:103] offset:17408
    ds_write_b128 v26, v[104:107] offset:18432
    ds_write_b128 v26, v[108:111] offset:19456
    ds_write_b128 v26, v[112:115] offset:20480
    ds_write_b128 v26, v[116:119] offset:21504
    ds_write_b128 v26, v[120:123] offset:22528
    ds_write_b128 v26, v[124:127] offset:23552
    ds_write_b128 v26, v[128:131] offset:24576
    ds_write_b128 v26, v[132:135] offset:25600
    ds_write_b128 v26, v[136:139] offset:26624
    ds_write_b128 v26, v[140:143] offset:27648
    ds_write_b128 v26, v[144:147] offset:28672
    ds_write_b128 v26, v[148:151] offset:29696
    ds_write_b128 v26, v[152:155] offset:30720
    ds_write_b128 v26, v[156:159] offset:31744
    ds_write_b128 v26, v[160:163] offset:32768
    ds_write_b128 v26, v[164:167] offset:33792
    s_waitcnt vmcnt(0)
    v_mov_b32 v24, 36
    ds_write_b32 v2, v24 offset:0
    s_waitcnt lgkmcnt(0)
    s_endpgm
L_Bidle:
    v_add_u32 v17, 7168, v16
    v_add_u32 v18, 14336, v16
    v_add_u32 v19, 21504, v16
    s_lshr_b32 s9, s70, 2
    s_lshl_b32 s9, s9, 7
    s_barrier
    v_lshlrev_b32 v26, 7, v1
    s_and_b32 s11, s70, 1
    s_mul_i32 s11, s11, 720896
    s_mul_i32 s12, s69, 11
    s_lshr_b32 s12, s12, 2
    s_mov_b32 s14, 2
    s_mul_i32 s13, s69, 6
    s_min_u32 s13, s13, 38
    s_lshl_b32 s13, s13, 13
    s_add_u32 s13, s13, s11
    s_add_u32 s13, s13, 180224
    s_add_u32 s11, s11, 540672
    buffer_load_dword v28, v26, s[56:59], s13 offen
    s_add_u32 s13, s13, 8192
    buffer_load_dword v28, v26, s[56:59], s13 offen
    s_add_u32 s13, s13, 8192
    buffer_load_dword v28, v26, s[56:59], s13 offen
    s_add_u32 s13, s13, 8192
    buffer_load_dword v28, v26, s[56:59], s13 offen
    s_add_u32 s13, s13, 8192
    buffer_load_dword v28, v26, s[56:59], s13 offen
    s_add_u32 s13, s13, 8192
    buffer_load_dword v28, v26, s[56:59], s13 offen
    s_add_u32 s13, s13, 8192
    s_mov_b32 s15, 30
L_Bi1:
    s_mov_b32 s13, 22
L_Bi2:
    s_lshl_b32 s8, s12, 13
    s_add_u32 s8, s8, s11
    buffer_load_dword v28, v26, s[56:59], s8 offen
    s_add_u32 s12, s12, 1
    s_cmp_eq_u32 s12, 22
    s_cselect_b32 s12, 0, s12
    s_waitcnt vmcnt(4)
    s_sub_u32 s15, s15, 1
    s_cmp_lg_u32 s15, 0
    s_cbranch_scc1 L_Bi3
    v_mov_b32 v24, 32
    ds_write_b32 v2, v24 offset:0
    ds_write_b32 v2, v24 offset:88
L_Bi3:
    s_sub_u32 s13, s13, 1
    s_cmp_lg_u32 s13, 0
    s_cbranch_scc1 L_Bi2
    s_sub_u32 s11, s11, 540672
    s_sub_u32 s14, s14, 1
    s_cmp_lg_u32 s14, 0
    s_cbranch_scc1 L_Bi1
    s_waitcnt vmcnt(0)
    s_add_u32 s14, s9, 540672
    buffer_load_dwordx4 v[32:35], v16, s[56:59], s14 offen
    s_add_u32 s14, s9, 548864
    buffer_load_dwordx4 v[36:39], v16, s[56:59], s14 offen
    s_add_u32 s14, s9, 557056
    buffer_load_dwordx4 v[40:43], v16, s[56:59], s14 offen
    s_add_u32 s14, s9, 565248
    buffer_load_dwordx4 v[44:47], v16, s[56:59], s14 offen
    s_add_u32 s14, s9, 573440
    buffer_load_dwordx4 v[48:51], v16, s[56:59], s14 offen
    s_add_u32 s14, s9, 581632
    buffer_load_dwordx4 v[52:55], v16, s[56:59], s14 offen
    s_add_u32 s14, s9, 589824
    buffer_load_dwordx4 v[56:59], v16, s[56:59], s14 offen
    s_add_u32 s14, s9, 598016
    buffer_load_dwordx4 v[60:63], v16, s[56:59], s14 offen
    s_add_u32 s14, s9, 606208
    buffer_load_dwordx4 v[64:67], v16, s[56:59], s14 offen
    s_add_u32 s14, s9, 614400
    buffer_load_dwordx4 v[68:71], v16, s[56:59], s14 offen
    s_add_u32 s14, s9, 622592
    buffer_load_dwordx4 v[72:75], v16, s[56:59], s14 offen
    s_add_u32 s14, s9, 630784
    buffer_load_dwordx4 v[76:79], v16, s[56:59], s14 offen
    s_add_u32 s14, s9, 638976
    buffer_load_dwordx4 v[80:83], v16, s[56:59], s14 offen
    s_add_u32 s14, s9, 647168
    buffer_load_dwordx4 v[84:87], v16, s[56:59], s14 offen
    s_add_u32 s14, s9, 655360
    buffer_load_dwordx4 v[88:91], v16, s[56:59], s14 offen
    s_add_u32 s14, s9, 663552
    buffer_load_dwordx4 v[92:95], v16, s[56:59], s14 offen
    s_add_u32 s14, s9, 671744
    buffer_load_dwordx4 v[96:99], v16, s[56:59], s14 offen
    s_add_u32 s14, s9, 679936
    buffer_load_dwordx4 v[100:103], v16, s[56:59], s14 offen
    s_add_u32 s14, s9, 688128
    buffer_load_dwordx4 v[104:107], v16, s[56:59], s14 offen
    s_add_u32 s14, s9, 696320
    buffer_load_dwordx4 v[108:111], v16, s[56:59], s14 offen
    s_add_u32 s14, s9, 704512
    buffer_load_dwordx4 v[112:115], v16, s[56:59], s14 offen
    s_add_u32 s14, s9, 712704
    buffer_load_dwordx4 v[116:119], v16, s[56:59], s14 offen
    s_add_u32 s14, s9, 1261568
    buffer_load_dwordx4 v[120:123], v16, s[56:59], s14 offen
    s_add_u32 s14, s9, 1269760
    buffer_load_dwordx4 v[124:127], v16, s[56:59], s14 offen
    s_add_u32 s14, s9, 1277952
    buffer_load_dwordx4 v[128:131], v16, s[56:59], s14 offen
    s_add_u32 s14, s9, 1286144
    buffer_load_dwordx4 v[132:135], v16, s[56:59], s14 offen
    s_add_u32 s14, s9, 1294336
    buffer_load_dwordx4 v[136:139], v16, s[56:59], s14 offen
    s_add_u32 s14, s9, 1302528
    buffer_load_dwordx4 v[140:143], v16, s[56:59], s14 offen
    s_add_u32 s14, s9, 1310720
    buffer_load_dwordx4 v[144:147], v16, s[56:59], s14 offen
    s_add_u32 s14, s9, 1318912
    buffer_load_dwordx4 v[148:151], v16, s[56:59], s14 offen
    s_add_u32 s14, s9, 1327104
    buffer_load_dwordx4 v[152:155], v16, s[56:59], s14 offen
    s_add_u32 s14, s9, 1335296
    buffer_load_dwordx4 v[156:159], v16, s[56:59], s14 offen
    s_add_u32 s14, s9, 1343488
    buffer_load_dwordx4 v[160:163], v16, s[56:59], s14 offen
    s_add_u32 s14, s9, 1351680
    buffer_load_dwordx4 v[164:167], v16, s[56:59], s14 offen
    s_branch L_Bwd
Lbs1:
    s_mov_b32 s5, 0x8000
Lp3:
    ds_read_b128 v[20:23], v2 offset:16
    s_waitcnt lgkmcnt(0)
    v_min3_u32 v20, v20, v21, v22
    v_min_u32 v20, v20, v23
    s_nop 0
    v_readfirstlane_b32 s4, v20
    s_nop 0
    s_cmp_ge_u32 s4, 1
    s_cbranch_scc1 Lpe4
    s_sub_u32 s5, s5, 1
    s_cmp_lg_u32 s5, 0
    s_cbranch_scc1 Lp3
Lpe4:
    s_branch Lbr2
Lbs5:
    s_mov_b32 s5, 0x8000
Lp7:
    ds_read_b128 v[20:23], v2 offset:16
    s_waitcnt lgkmcnt(0)
    v_min3_u32 v20, v20, v21, v22
    v_min_u32 v20, v20, v23
    s_nop 0
    v_readfirstlane_b32 s4, v20
    s_nop 0
    s_cmp_ge_u32 s4, 2
    s_cbranch_scc1 Lpe8
    s_sub_u32 s5, s5, 1
    s_cmp_lg_u32 s5, 0
    s_cbranch_scc1 Lp7
Lpe8:
    s_branch Lbr6
Lbs9:
    s_mov_b32 s5, 0x8000
Lp11:
    ds_read_b128 v[20:23], v2 offset:16
    s_waitcnt lgkmcnt(0)
    v_min3_u32 v20, v20, v21, v22
    v_min_u32 v20, v20, v23
    s_nop 0
    v_readfirstlane_b32 s4, v20
    s_nop 0
    s_cmp_ge_u32 s4, 3
    s_cbranch_scc1 Lpe12
    s_sub_u32 s5, s5, 1
    s_cmp_lg_u32 s5, 0
    s_cbranch_scc1 Lp11
Lpe12:
    s_branch Lbr10
Lbs13:
    s_mov_b32 s5, 0x8000
Lp15:
    ds_read_b128 v[20:23], v2 offset:16
    s_waitcnt lgkmcnt(0)
    v_min3_u32 v20, v20, v21, v22
    v_min_u32 v20, v20, v23
    s_nop 0
    v_readfirstlane_b32 s4, v20
    s_nop 0
    s_cmp_ge_u32 s4, 4
    s_cbranch_scc1 Lpe16
    s_sub_u32 s5, s5, 1
    s_cmp_lg_u32 s5, 0
    s_cbranch_scc1 Lp15
Lpe16:
    s_branch Lbr14
Lbs17:
    s_mov_b32 s5, 0x8000
Lp19:
    ds_read_b128 v[20:23], v2 offset:16
    s_waitcnt lgkmcnt(0)
    v_min3_u32 v20, v20, v21, v22
    v_min_u32 v20, v20, v23
    s_nop 0
    v_readfirstlane_b32 s4, v20
    s_nop 0
    s_cmp_ge_u32 s4, 5
    s_cbranch_scc1 Lpe20
    s_sub_u32 s5, s5, 1
    s_cmp_lg_u32 s5, 0
    s_cbranch_scc1 Lp19
Lpe20:
    s_branch Lbr18
L_A:
    s_setprio 2
    v_and_b32 v3, 3, v1
    v_lshlrev_b32 v3, 7, v3
    v_bfe_u32 v4, v1, 2, 1
    v_mul_u32_u24 v4, 262144, v4
    v_add_u32 v3, v3, v4
    s_lshl_b32 s6, s2, 9
    s_add_u32 s6, s6, 393216
    buffer_load_dword v60, v3, s[64:67], s6 offen sc1
    v_lshrrev_b32 v4, 4, v1
    v_and_b32 v3, 7, v1
    v_mul_u32_u24 v3, 1056, v3
    v_bfe_u32 v6, v1, 3, 1
    v_lshl_add_u32 v3, v6, 9, v3
    v_lshl_add_u32 v3, v4, 4, v3
    v_add_u32 v3, 152064, v3
    v_bfe_u32 v6, v1, 2, 2
    v_cmp_eq_u32 s[14:15], v4, v6
    v_mul_u32_u24 v6, 1056, v6
    v_lshl_add_u32 v6, v4, 5, v6
    v_and_b32 v7, 3, v1
    v_lshl_add_u32 v6, v7, 3, v6
    v_add_u32 v6, 152064, v6
    v_cmp_eq_u32 s[8:9], 1, v7
    v_cmp_eq_u32 s[10:11], 2, v7
    v_cmp_eq_u32 s[12:13], 3, v7
    v_mov_b32 v20, 0x3f803f80
    v_mov_b32 v21, 0x3f803f80
    v_mov_b32 v22, 0x3f803f80
    v_mov_b32 v23, 0x3f803f80
    s_waitcnt lgkmcnt(0)
    s_barrier
    s_add_u32 s68, s68, 1
    s_waitcnt vmcnt(1)
    ds_read_b128 v[64:67], v3 offset:0
    ds_read_b128 v[68:71], v3 offset:64
    ds_read_b128 v[72:75], v3 offset:128
    ds_read_b128 v[76:79], v3 offset:192
    ds_read_b128 v[80:83], v3 offset:256
    ds_read_b128 v[84:87], v3 offset:320
    ds_read_b128 v[88:91], v3 offset:384
    ds_read_b128 v[92:95], v3 offset:448
    s_waitcnt lgkmcnt(7)
    v_mfma_f32_16x16x32_bf16 v[24:27], v[64:67], v[64:67], 0
    v_mfma_f32_16x16x32_bf16 v[28:31], v[20:23], v[64:67], 0
    s_waitcnt lgkmcnt(6)
    v_mfma_f32_16x16x32_bf16 v[24:27], v[68:71], v[68:71], v[24:27]
    v_mfma_f32_16x16x32_bf16 v[28:31], v[20:23], v[68:71], v[28:31]
    s_waitcnt lgkmcnt(5)
    v_mfma_f32_16x16x32_bf16 v[24:27], v[72:75], v[72:75], v[24:27]
    v_mfma_f32_16x16x32_bf16 v[28:31], v[20:23], v[72:75], v[28:31]
    s_waitcnt lgkmcnt(4)
    v_mfma_f32_16x16x32_bf16 v[24:27], v[76:79], v[76:79], v[24:27]
    v_mfma_f32_16x16x32_bf16 v[28:31], v[20:23], v[76:79], v[28:31]
    s_waitcnt lgkmcnt(3)
    v_mfma_f32_16x16x32_bf16 v[24:27], v[80:83], v[80:83], v[24:27]
    v_mfma_f32_16x16x32_bf16 v[28:31], v[20:23], v[80:83], v[28:31]
    s_waitcnt lgkmcnt(2)
    v_mfma_f32_16x16x32_bf16 v[24:27], v[84:87], v[84:87], v[24:27]
    v_mfma_f32_16x16x32_bf16 v[28:31], v[20:23], v[84:87], v[28:31]
    s_waitcnt lgkmcnt(1)
    v_mfma_f32_16x16x32_bf16 v[24:27], v[88:91], v[88:91], v[24:27]
    v_mfma_f32_16x16x32_bf16 v[28:31], v[20:23], v[88:91], v[28:31]
    s_waitcnt lgkmcnt(0)
    v_mfma_f32_16x16x32_bf16 v[24:27], v[92:95], v[92:95], v[24:27]
    v_mfma_f32_16x16x32_bf16 v[28:31], v[20:23], v[92:95], v[28:31]
    ds_read_b64_tr_b16 v[96:97], v6 offset:0
    ds_read_b64_tr_b16 v[98:99], v6 offset:4224
    ds_read_b64_tr_b16 v[100:101], v6 offset:128
    ds_read_b64_tr_b16 v[102:103], v6 offset:4352
    ds_read_b64_tr_b16 v[104:105], v6 offset:256
    ds_read_b64_tr_b16 v[106:107], v6 offset:4480
    ds_read_b64_tr_b16 v[108:109], v6 offset:384
    ds_read_b64_tr_b16 v[110:111], v6 offset:4608
    ds_read_b64_tr_b16 v[112:113], v6 offset:512
    ds_read_b64_tr_b16 v[114:115], v6 offset:4736
    ds_read_b64_tr_b16 v[116:117], v6 offset:640
    ds_read_b64_tr_b16 v[118:119], v6 offset:4864
    ds_read_b64_tr_b16 v[120:121], v6 offset:768
    ds_read_b64_tr_b16 v[122:123], v6 offset:4992
    ds_read_b64_tr_b16 v[124:125], v6 offset:896
    ds_read_b64_tr_b16 v[126:127], v6 offset:5120
    v_cndmask_b32 v56, v24, v25, s[8:9]
    v_cndmask_b32 v56, v56, v26, s[10:11]
    v_cndmask_b32 v56, v56, v27, s[12:13]
    v_cndmask_b32 v56, 0, v56, s[14:15]
    v_mov_b32 v57, v56
    s_nop 1
    v_permlane32_swap_b32 v56, v57
    v_add_f32 v56, v56, v57
    v_mov_b32 v57, v56
    s_nop 1
    v_permlane16_swap_b32 v56, v57
    v_add_f32 v56, v56, v57
    s_nop 1
    v_add_f32_dpp v56, v56, v56 row_ror:8 row_mask:0xf bank_mask:0xf
    v_add_f32_dpp v57, v28, v28 row_ror:8 row_mask:0xf bank_mask:0xf
    v_mul_f32 v57, 0x3b000000, v57
    v_mul_f32 v56, 0x3b000000, v56
    v_fma_f32 v56, -v57, v57, v56
    v_max_f32 v56, 0, v56
    v_cvt_pk_bf16_f32 v56, v56, v56
    v_and_b32 v56, 0xffff0000, v56
    v_add_f32 v56, 0x3727c5ac, v56
    v_cvt_pk_bf16_f32 v56, v56, v56
    v_and_b32 v56, 0xffff0000, v56
    v_sqrt_f32 v56, v56
    s_nop 0
    v_cvt_pk_bf16_f32 v58, v57, v56
    v_mov_b32 v59, s68
    s_lshl_b32 s6, s75, 6
    s_add_u32 s6, s6, 65536
    v_lshlrev_b32 v7, 3, v1
    s_mov_b32 s14, s6
    v_and_b32 v56, 0xffff0000, v58
    v_rcp_f32 v56, v56
    v_lshlrev_b32 v57, 16, v58
    v_mul_f32 v57, v57, v56
    v_mov_b32_dpp v32, v56 row_newbcast:0 row_mask:0xf bank_mask:0xf
    s_nop 0
    v_mov_b32_dpp v40, v57 row_newbcast:0 row_mask:0xf bank_mask:0xf
    v_mov_b32_dpp v33, v56 row_newbcast:1 row_mask:0xf bank_mask:0xf
    v_mov_b32_dpp v41, v57 row_newbcast:1 row_mask:0xf bank_mask:0xf
    v_mov_b32_dpp v34, v56 row_newbcast:2 row_mask:0xf bank_mask:0xf
    v_mov_b32_dpp v42, v57 row_newbcast:2 row_mask:0xf bank_mask:0xf
    v_mov_b32_dpp v35, v56 row_newbcast:3 row_mask:0xf bank_mask:0xf
    v_mov_b32_dpp v43, v57 row_newbcast:3 row_mask:0xf bank_mask:0xf
    v_mov_b32_dpp v36, v56 row_newbcast:4 row_mask:0xf bank_mask:0xf
    v_mov_b32_dpp v44, v57 row_newbcast:4 row_mask:0xf bank_mask:0xf
    v_mov_b32_dpp v37, v56 row_newbcast:5 row_mask:0xf bank_mask:0xf
    v_mov_b32_dpp v45, v57 row_newbcast:5 row_mask:0xf bank_mask:0xf
    v_mov_b32_dpp v38, v56 row_newbcast:6 row_mask:0xf bank_mask:0xf
    v_mov_b32_dpp v46, v57 row_newbcast:6 row_mask:0xf bank_mask:0xf
    v_mov_b32_dpp v39, v56 row_newbcast:7 row_mask:0xf bank_mask:0xf
    v_mov_b32_dpp v47, v57 row_newbcast:7 row_mask:0xf bank_mask:0xf
    s_lshl_b32 s6, s75, 13
    s_add_u32 s6, s6, 1048576
    s_add_u32 s7, s6, 4096
    s_waitcnt lgkmcnt(0)
    v_lshlrev_b32 v48, 16, v96
    v_and_b32 v49, 0xffff0000, v96
    v_lshlrev_b32 v50, 16, v97
    v_and_b32 v51, 0xffff0000, v97
    v_lshlrev_b32 v52, 16, v98
    v_and_b32 v53, 0xffff0000, v98
    v_lshlrev_b32 v54, 16, v99
    v_and_b32 v55, 0xffff0000, v99
    v_fma_f32 v48, v48, v32, -v40
    v_fma_f32 v49, v49, v33, -v41
    v_fma_f32 v50, v50, v34, -v42
    v_fma_f32 v51, v51, v35, -v43
    v_fma_f32 v52, v52, v36, -v44
    v_fma_f32 v53, v53, v37, -v45
    v_fma_f32 v54, v54, v38, -v46
    v_fma_f32 v55, v55, v39, -v47
    v_cvt_pk_bf16_f32 v96, v48, v49
    v_cvt_pk_bf16_f32 v97, v50, v51
    v_cvt_pk_bf16_f32 v98, v52, v53
    v_cvt_pk_bf16_f32 v99, v54, v55
    v_lshlrev_b32 v48, 16, v100
    v_and_b32 v49, 0xffff0000, v100
    v_lshlrev_b32 v50, 16, v101
    v_and_b32 v51, 0xffff0000, v101
    v_lshlrev_b32 v52, 16, v102
    v_and_b32 v53, 0xffff0000, v102
    v_lshlrev_b32 v54, 16, v103
    v_and_b32 v55, 0xffff0000, v103
    v_fma_f32 v48, v48, v32, -v40
    v_fma_f32 v49, v49, v33, -v41
    v_fma_f32 v50, v50, v34, -v42
    v_fma_f32 v51, v51, v35, -v43
    v_fma_f32 v52, v52, v36, -v44
    v_fma_f32 v53, v53, v37, -v45
    v_fma_f32 v54, v54, v38, -v46
    v_fma_f32 v55, v55, v39, -v47
    v_cvt_pk_bf16_f32 v100, v48, v49
    v_cvt_pk_bf16_f32 v101, v50, v51
    v_cvt_pk_bf16_f32 v102, v52, v53
    v_cvt_pk_bf16_f32 v103, v54, v55
    v_lshlrev_b32 v48, 16, v104
    v_and_b32 v49, 0xffff0000, v104
    v_lshlrev_b32 v50, 16, v105
    v_and_b32 v51, 0xffff0000, v105
    v_lshlrev_b32 v52, 16, v106
    v_and_b32 v53, 0xffff0000, v106
    v_lshlrev_b32 v54, 16, v107
    v_and_b32 v55, 0xffff0000, v107
    v_fma_f32 v48, v48, v32, -v40
    v_fma_f32 v49, v49, v33, -v41
    v_fma_f32 v50, v50, v34, -v42
    v_fma_f32 v51, v51, v35, -v43
    v_fma_f32 v52, v52, v36, -v44
    v_fma_f32 v53, v53, v37, -v45
    v_fma_f32 v54, v54, v38, -v46
    v_fma_f32 v55, v55, v39, -v47
    v_cvt_pk_bf16_f32 v104, v48, v49
    v_cvt_pk_bf16_f32 v105, v50, v51
    v_cvt_pk_bf16_f32 v106, v52, v53
    v_cvt_pk_bf16_f32 v107, v54, v55
    v_lshlrev_b32 v48, 16, v108
    v_and_b32 v49, 0xffff0000, v108
    v_lshlrev_b32 v50, 16, v109
    v_and_b32 v51, 0xffff0000, v109
    v_lshlrev_b32 v52, 16, v110
    v_and_b32 v53, 0xffff0000, v110
    v_lshlrev_b32 v54, 16, v111
    v_and_b32 v55, 0xffff0000, v111
    v_fma_f32 v48, v48, v32, -v40
    v_fma_f32 v49, v49, v33, -v41
    v_fma_f32 v50, v50, v34, -v42
    v_fma_f32 v51, v51, v35, -v43
    v_fma_f32 v52, v52, v36, -v44
    v_fma_f32 v53, v53, v37, -v45
    v_fma_f32 v54, v54, v38, -v46
    v_fma_f32 v55, v55, v39, -v47
    v_cvt_pk_bf16_f32 v108, v48, v49
    v_cvt_pk_bf16_f32 v109, v50, v51
    v_cvt_pk_bf16_f32 v110, v52, v53
    v_cvt_pk_bf16_f32 v111, v54, v55
    v_lshlrev_b32 v48, 16, v112
    v_and_b32 v49, 0xffff0000, v112
    v_lshlrev_b32 v50, 16, v113
    v_and_b32 v51, 0xffff0000, v113
    v_lshlrev_b32 v52, 16, v114
    v_and_b32 v53, 0xffff0000, v114
    v_lshlrev_b32 v54, 16, v115
    v_and_b32 v55, 0xffff0000, v115
    v_fma_f32 v48, v48, v32, -v40
    v_fma_f32 v49, v49, v33, -v41
    v_fma_f32 v50, v50, v34, -v42
    v_fma_f32 v51, v51, v35, -v43
    v_fma_f32 v52, v52, v36, -v44
    v_fma_f32 v53, v53, v37, -v45
    v_fma_f32 v54, v54, v38, -v46
    v_fma_f32 v55, v55, v39, -v47
    v_cvt_pk_bf16_f32 v112, v48, v49
    v_cvt_pk_bf16_f32 v113, v50, v51
    v_cvt_pk_bf16_f32 v114, v52, v53
    v_cvt_pk_bf16_f32 v115, v54, v55
    v_lshlrev_b32 v48, 16, v116
    v_and_b32 v49, 0xffff0000, v116
    v_lshlrev_b32 v50, 16, v117
    v_and_b32 v51, 0xffff0000, v117
    v_lshlrev_b32 v52, 16, v118
    v_and_b32 v53, 0xffff0000, v118
    v_lshlrev_b32 v54, 16, v119
    v_and_b32 v55, 0xffff0000, v119
    v_fma_f32 v48, v48, v32, -v40
    v_fma_f32 v49, v49, v33, -v41
    v_fma_f32 v50, v50, v34, -v42
    v_fma_f32 v51, v51, v35, -v43
    v_fma_f32 v52, v52, v36, -v44
    v_fma_f32 v53, v53, v37, -v45
    v_fma_f32 v54, v54, v38, -v46
    v_fma_f32 v55, v55, v39, -v47
    v_cvt_pk_bf16_f32 v116, v48, v49
    v_cvt_pk_bf16_f32 v117, v50, v51
    v_cvt_pk_bf16_f32 v118, v52, v53
    v_cvt_pk_bf16_f32 v119, v54, v55
    v_lshlrev_b32 v48, 16, v120
    v_and_b32 v49, 0xffff0000, v120
    v_lshlrev_b32 v50, 16, v121
    v_and_b32 v51, 0xffff0000, v121
    v_lshlrev_b32 v52, 16, v122
    v_and_b32 v53, 0xffff0000, v122
    v_lshlrev_b32 v54, 16, v123
    v_and_b32 v55, 0xffff0000, v123
    v_fma_f32 v48, v48, v32, -v40
    v_fma_f32 v49, v49, v33, -v41
    v_fma_f32 v50, v50, v34, -v42
    v_fma_f32 v51, v51, v35, -v43
    v_fma_f32 v52, v52, v36, -v44
    v_fma_f32 v53, v53, v37, -v45
    v_fma_f32 v54, v54, v38, -v46
    v_fma_f32 v55, v55, v39, -v47
    v_cvt_pk_bf16_f32 v120, v48, v49
    v_cvt_pk_bf16_f32 v121, v50, v51
    v_cvt_pk_bf16_f32 v122, v52, v53
    v_cvt_pk_bf16_f32 v123, v54, v55
    v_lshlrev_b32 v48, 16, v124
    v_and_b32 v49, 0xffff0000, v124
    v_lshlrev_b32 v50, 16, v125
    v_and_b32 v51, 0xffff0000, v125
    v_lshlrev_b32 v52, 16, v126
    v_and_b32 v53, 0xffff0000, v126
    v_lshlrev_b32 v54, 16, v127
    v_and_b32 v55, 0xffff0000, v127
    v_fma_f32 v48, v48, v32, -v40
    v_fma_f32 v49, v49, v33, -v41
    v_fma_f32 v50, v50, v34, -v42
    v_fma_f32 v51, v51, v35, -v43
    v_fma_f32 v52, v52, v36, -v44
    v_fma_f32 v53, v53, v37, -v45
    v_fma_f32 v54, v54, v38, -v46
    v_fma_f32 v55, v55, v39, -v47
    v_cvt_pk_bf16_f32 v124, v48, v49
    v_cvt_pk_bf16_f32 v125, v50, v51
    v_cvt_pk_bf16_f32 v126, v52, v53
    v_cvt_pk_bf16_f32 v127, v54, v55
    s_cmp_eq_u32 s74, 2
    s_cbranch_scc1 La29
    s_mov_b32 s5, 0x8000
Lp30:
    ds_read_b32 v24, v2 offset:0
    s_waitcnt lgkmcnt(0)
    v_readfirstlane_b32 s4, v24
    s_nop 0
    s_cmp_ge_u32 s4, 8
    s_cbranch_scc1 Lpe31
    s_sleep 2
    s_sub_u32 s5, s5, 1
    s_cmp_lg_u32 s5, 0
    s_cbranch_scc1 Lp30
Lpe31:
La29:
    buffer_store_dwordx4 v[96:99], v5, s[64:67], s6 offen offset:0 sc1
    buffer_store_dwordx4 v[100:103], v5, s[64:67], s6 offen offset:1024 sc1
    buffer_store_dwordx4 v[104:107], v5, s[64:67], s6 offen offset:2048 sc1
    buffer_store_dwordx4 v[108:111], v5, s[64:67], s6 offen offset:3072 sc1
    buffer_store_dwordx4 v[112:115], v5, s[64:67], s7 offen offset:0 sc1
    buffer_store_dwordx4 v[116:119], v5, s[64:67], s7 offen offset:1024 sc1
    buffer_store_dwordx4 v[120:123], v5, s[64:67], s7 offen offset:2048 sc1
    buffer_store_dwordx4 v[124:127], v5, s[64:67], s7 offen offset:3072 sc1
    s_mov_b64 exec, 0xff
    buffer_store_dwordx2 v[58:59], v7, s[64:67], s14 offen sc1
    s_mov_b64 exec, -1
    v_add_u32 v7, 152064, v7
    v_mov_b32 v32, 0
    v_mov_b32 v33, 0
    ds_write_b64 v7, v[32:33]
    ds_write_b64 v7, v[32:33] offset:4608
    s_waitcnt vmcnt(0)
    s_lshl_b32 s6, s2, 2
    s_add_u32 s6, s6, 32768
    s_mov_b64 exec, 1
    buffer_store_dword v59, v32, s[64:67], s6 offen sc1
    s_mov_b64 exec, -1
    s_cmp_eq_u32 s74, 2
    s_cbranch_scc1 La32
    v_and_b32 v30, 31, v1
    v_lshrrev_b32 v31, 5, v1
    v_mul_u32_u24 v7, 384, v31
    v_lshl_add_u32 v7, v30, 2, v7
    v_add_u32 v7, 161280, v7
    s_mov_b32 s5, 0x8000
Lp33:
    ds_read_b32 v24, v2 offset:84
    s_waitcnt lgkmcnt(0)
    v_readfirstlane_b32 s4, v24
    s_nop 0
    s_cmp_ge_u32 s4, 2
    s_cbranch_scc1 Lpe34
    s_sleep 2
    s_sub_u32 s5, s5, 1
    s_cmp_lg_u32 s5, 0
    s_cbranch_scc1 Lp33
Lpe34:
    ds_read_b32 v56, v7 offset:0
    ds_read_b32 v57, v7 offset:128
    ds_read_b32 v58, v7 offset:256
    s_lshl_b32 s8, s72, 14
    s_lshl_b32 s9, s71, 10
    s_add_u32 s8, s8, s9
    s_add_u32 s8, s8, 131072
    s_waitcnt lgkmcnt(0)
    buffer_store_dwordx4 v[56:59], v5, s[64:67], s8 offen sc1
La32:
    v_lshrrev_b32 v6, 1, v1
    v_lshlrev_b32 v34, 4, v6
    v_lshlrev_b32 v6, 13, v6
    v_and_b32 v3, 1, v1
    v_lshl_add_u32 v6, v3, 4, v6
    s_lshl_b32 s13, s75, 5
    s_add_u32 s13, s13, 1048576
    v_mul_u32_u24 v3, 4608, v3
    v_add_u32 v34, v34, v3
    v_add_u32 v34, 152576, v34
    s_lshl_b32 s6, s71, 10
    s_add_u32 s6, s6, 65536
    s_and_b32 s8, s71, 8
    s_lshl_b32 s8, s8, 10
    s_lshl_b32 s7, s72, 14
    s_add_u32 s7, s7, s8
    s_add_u32 s7, s7, 131072
    s_add_u32 s15, s7, 4096
    s_mov_b32 s5, 0x8000
Lp35:
    ds_read_b32 v28, v2 offset:0
    s_waitcnt lgkmcnt(0)
    v_readfirstlane_b32 s4, v28
    s_nop 0
    s_cmp_ge_u32 s4, 22
    s_cbranch_scc1 Lpe36
    s_sleep 2
    s_sub_u32 s5, s5, 1
    s_cmp_lg_u32 s5, 0
    s_cbranch_scc1 Lp35
Lpe36:
    s_mov_b32 s12, 0x4000
La37:
    s_mov_b32 s8, 32768
    buffer_load_dwordx4 v[52:55], v5, s[64:67], s8 offen sc1
    buffer_load_dwordx4 v[24:27], v5, s[64:67], s6 offen sc1
    buffer_load_dwordx4 v[64:67], v5, s[64:67], s7 offen offset:0 sc1
    buffer_load_dwordx4 v[68:71], v5, s[64:67], s7 offen offset:1024 sc1
    buffer_load_dwordx4 v[72:75], v5, s[64:67], s7 offen offset:2048 sc1
    buffer_load_dwordx4 v[76:79], v5, s[64:67], s7 offen offset:3072 sc1
    buffer_load_dwordx4 v[80:83], v5, s[64:67], s15 offen offset:0 sc1
    buffer_load_dwordx4 v[84:87], v5, s[64:67], s15 offen offset:1024 sc1
    buffer_load_dwordx4 v[88:91], v5, s[64:67], s15 offen offset:2048 sc1
    buffer_load_dwordx4 v[92:95], v5, s[64:67], s15 offen offset:3072 sc1
    s_waitcnt vmcnt(0)
    v_min_u32 v30, v25, v27
    v_max_u32 v31, v25, v27
    v_min3_u32 v30, v30, v52, v53
    v_max3_u32 v31, v31, v52, v53
    v_min3_u32 v30, v30, v54, v55
    v_max3_u32 v31, v31, v54, v55
    v_min3_u32 v30, v30, v67, v71
    v_max3_u32 v31, v31, v67, v71
    v_min3_u32 v30, v30, v75, v79
    v_max3_u32 v31, v31, v75, v79
    v_min3_u32 v30, v30, v83, v87
    v_max3_u32 v31, v31, v83, v87
    v_min3_u32 v30, v30, v91, v95
    v_max3_u32 v31, v31, v91, v95
    v_cmp_ne_u32 vcc, s68, v30
    v_cmp_ne_u32 s[8:9], s68, v31
    s_nop 0
    s_or_b64 vcc, vcc, s[8:9]
    s_cbranch_vccz La38
    s_sleep 4
    s_sub_u32 s12, s12, 1
    s_cmp_lg_u32 s12, 0
    s_cbranch_scc1 La37
La38:
    v_add_f32 v64, v64, v80
    v_add_f32 v65, v65, v81
    v_add_f32 v66, v66, v82
    v_add_f32 v68, v68, v84
    v_add_f32 v69, v69, v85
    v_add_f32 v70, v70, v86
    v_add_f32 v72, v72, v88
    v_add_f32 v73, v73, v89
    v_add_f32 v74, v74, v90
    v_add_f32 v76, v76, v92
    v_add_f32 v77, v77, v93
    v_add_f32 v78, v78, v94
    v_add_f32 v64, v64, v72
    v_add_f32 v65, v65, v73
    v_add_f32 v66, v66, v74
    v_add_f32 v68, v68, v76
    v_add_f32 v69, v69, v77
    v_add_f32 v70, v70, v78
    v_add_f32 v64, v64, v68
    v_add_f32 v65, v65, v69
    v_add_f32 v66, v66, v70
    v_lshlrev_b32 v30, 3, v1
    v_add_u32 v30, 162816, v30
    ds_write2_b32 v30, v24, v26 offset0:0 offset1:1
    v_and_b32 v30, 31, v1
    v_lshlrev_b32 v30, 3, v30
    v_lshrrev_b32 v31, 5, v1
    v_mul_u32_u24 v31, 768, v31
    v_add_u32 v30, v30, v31
    v_add_u32 v30, 161280, v30
    s_mov_b32 s8, 0x07060302
    v_and_b32 v40, 0xffff0000, v64
    v_sub_f32 v41, v64, v40
    v_and_b32 v42, 0xffff0000, v41
    v_sub_f32 v43, v41, v42
    v_perm_b32 v42, v42, v40, s8
    v_lshrrev_b32 v43, 16, v43
    ds_write_b64 v30, v[42:43] offset:0
    v_and_b32 v44, 0xffff0000, v65
    v_sub_f32 v45, v65, v44
    v_and_b32 v46, 0xffff0000, v45
    v_sub_f32 v47, v45, v46
    v_perm_b32 v46, v46, v44, s8
    v_lshrrev_b32 v47, 16, v47
    ds_write_b64 v30, v[46:47] offset:256
    v_and_b32 v48, 0xffff0000, v66
    v_sub_f32 v49, v66, v48
    v_and_b32 v50, 0xffff0000, v49
    v_sub_f32 v51, v49, v50
    v_perm_b32 v50, v50, v48, s8
    v_lshrrev_b32 v51, 16, v51
    ds_write_b64 v30, v[50:51] offset:512
    v_mov_b32 v31, 1
    ds_write_b32 v2, v31 offset:32
    s_mov_b32 s5, 0x8000
Lp39:
    ds_read_b32 v28, v2 offset:88
    s_waitcnt lgkmcnt(0)
    v_readfirstlane_b32 s4, v28
    s_nop 0
    s_cmp_ge_u32 s4, 1
    s_cbranch_scc1 Lpe40
    s_sleep 1
    s_sub_u32 s5, s5, 1
    s_cmp_lg_u32 s5, 0
    s_cbranch_scc1 Lp39
Lpe40:
    s_add_u32 s8, s13, 0
    buffer_load_dwordx4 v[96:99], v6, s[64:67], s8 offen sc1
    s_add_u32 s8, s13, 262144
    buffer_load_dwordx4 v[100:103], v6, s[64:67], s8 offen sc1
    s_add_u32 s8, s13, 524288
    buffer_load_dwordx4 v[104:107], v6, s[64:67], s8 offen sc1
    s_add_u32 s8, s13, 786432
    buffer_load_dwordx4 v[108:111], v6, s[64:67], s8 offen sc1
    s_add_u32 s8, s13, 1048576
    buffer_load_dwordx4 v[112:115], v6, s[64:67], s8 offen sc1
    s_add_u32 s8, s13, 1310720
    buffer_load_dwordx4 v[116:119], v6, s[64:67], s8 offen sc1
    s_add_u32 s8, s13, 1572864
    buffer_load_dwordx4 v[120:123], v6, s[64:67], s8 offen sc1
    s_add_u32 s8, s13, 1835008
    buffer_load_dwordx4 v[124:127], v6, s[64:67], s8 offen sc1
    v_lshrrev_b32 v3, 3, v1
    v_mul_u32_u24 v3, 3072, v3
    v_add_u32 v12, v3, v16
    v_add_u32 v13, 31744, v12
    v_add_u32 v14, 63488, v12
    v_add_u32 v15, 95232, v12
    s_lshl_b32 s6, s69, 2
    s_and_b32 s7, s70, 3
    s_add_u32 s6, s6, s7
    s_lshr_b32 s7, s70, 2
    s_lshr_b32 s12, s6, 4
    s_lshl_b32 s12, s12, 3
    s_add_u32 s12, s12, s7
    s_lshl_b32 s12, s12, 13
    s_add_u32 s12, s12, 655360
    s_lshl_b32 s11, s7, 18
    s_lshl_b32 s10, s6, 7
    s_add_u32 s11, s11, s10
    s_add_u32 s11, s11, 14680064
    s_lshl_b32 s10, s6, 16
    s_lshl_b32 s9, s7, 7
    s_add_u32 s10, s10, s9
    v_lshlrev_b32 v27, 7, v1
    s_waitcnt vmcnt(0)
    ds_write_b128 v34, v[96:99] offset:0
    ds_write_b128 v34, v[100:103] offset:512
    ds_write_b128 v34, v[104:107] offset:1024
    ds_write_b128 v34, v[108:111] offset:1536
    ds_write_b128 v34, v[112:115] offset:2048
    ds_write_b128 v34, v[116:119] offset:2560
    ds_write_b128 v34, v[120:123] offset:3072
    ds_write_b128 v34, v[124:127] offset:3584
    v_mov_b32 v31, 1
    ds_write_b32 v2, v31 offset:36
    s_mov_b32 s5, 0x8000
Lp41:
    ds_read_b32 v28, v2 offset:80
    s_waitcnt lgkmcnt(0)
    v_readfirstlane_b32 s4, v28
    s_nop 0
    s_cmp_ge_u32 s4, 4
    s_cbranch_scc1 Lpe42
    s_sleep 2
    s_sub_u32 s5, s5, 1
    s_cmp_lg_u32 s5, 0
    s_cbranch_scc1 Lp41
Lpe42:
    s_mov_b32 m0, 143360
    s_add_u32 s8, s10, 0
    buffer_load_dwordx4 v8, s[44:47], s8 offen offset:0 lds
    buffer_load_dwordx4 v9, s[44:47], s8 offen offset:1024 lds
    buffer_load_dwordx4 v10, s[44:47], s8 offen offset:2048 lds
    buffer_load_dwordx4 v11, s[44:47], s8 offen offset:3072 lds
    s_mov_b32 m0, 147456
    s_add_u32 s8, s10, 32768
    buffer_load_dwordx4 v8, s[44:47], s8 offen offset:0 lds
    buffer_load_dwordx4 v9, s[44:47], s8 offen offset:1024 lds
    buffer_load_dwordx4 v10, s[44:47], s8 offen offset:2048 lds
    buffer_load_dwordx4 v11, s[44:47], s8 offen offset:3072 lds
    s_mov_b32 s5, 0x8000
Lp43:
    ds_read_b128 v[20:23], v2 offset:16
    s_waitcnt lgkmcnt(0)
    v_min3_u32 v20, v20, v21, v22
    v_min_u32 v20, v20, v23
    s_nop 0
    v_readfirstlane_b32 s4, v20
    s_nop 0
    s_cmp_ge_u32 s4, 11
    s_cbranch_scc1 Lpe44
    s_sleep 2
    s_sub_u32 s5, s5, 1
    s_cmp_lg_u32 s5, 0
    s_cbranch_scc1 Lp43
Lpe44:
    s_mov_b32 s5, 0x4000
Lf45:
    buffer_load_dword v28, v27, s[64:67], s12 offen sc1
    s_waitcnt vmcnt(0)
    v_cmp_ne_u32 vcc, s68, v28
    s_cbranch_vccz Lfe46
    s_sleep 4
    s_sub_u32 s5, s5, 1
    s_cmp_lg_u32 s5, 0
    s_cbranch_scc1 Lf45
Lfe46:
    s_mov_b32 m0, 135168
    s_add_u32 s8, s11, 0
    buffer_load_dwordx4 v12, s[64:67], s8 offen offset:0 sc1 lds
    buffer_load_dwordx4 v13, s[64:67], s8 offen offset:1024 sc1 lds
    buffer_load_dwordx4 v14, s[64:67], s8 offen offset:2048 sc1 lds
    buffer_load_dwordx4 v15, s[64:67], s8 offen offset:3072 sc1 lds
    s_mov_b32 m0, 139264
    s_add_u32 s8, s11, 131072
    buffer_load_dwordx4 v12, s[64:67], s8 offen offset:0 sc1 lds
    buffer_load_dwordx4 v13, s[64:67], s8 offen offset:1024 sc1 lds
    buffer_load_dwordx4 v14, s[64:67], s8 offen offset:2048 sc1 lds
    buffer_load_dwordx4 v15, s[64:67], s8 offen offset:3072 sc1 lds
    s_mov_b32 s5, 0x8000
Lp47:
    ds_read_b128 v[20:23], v2 offset:16
    s_waitcnt lgkmcnt(0)
    v_min3_u32 v20, v20, v21, v22
    v_min_u32 v20, v20, v23
    s_nop 0
    v_readfirstlane_b32 s4, v20
    s_nop 0
    s_cmp_ge_u32 s4, 11
    s_cbranch_scc1 Lpe48
    s_sleep 1
    s_sub_u32 s5, s5, 1
    s_cmp_lg_u32 s5, 0
    s_cbranch_scc1 Lp47
Lpe48:
    s_waitcnt vmcnt(0)
    v_mov_b32 v24, 1
    ds_write_b32 v2, v24 offset:92
    s_waitcnt lgkmcnt(0)
    s_endpgm
L_H:
    s_mul_i32 s13, s14, 8448
    s_add_u32 s13, s13, 135168
    s_lshl_b32 s12, s15, 12
    s_add_u32 s12, s12, s13
    v_and_b32 v28, 15, v1
    v_lshrrev_b32 v29, 4, v1
    v_add_u32 v30, v28, v29
    v_lshlrev_b32 v30, 4, v30
    v_lshl_add_u32 v31, v28, 8, s12
    v_add_u32 v4, 0, v30
    v_and_b32 v4, 0xff, v4
    v_add_u32 v4, v4, v31
    v_add_u32 v5, 64, v30
    v_and_b32 v5, 0xff, v5
    v_add_u32 v5, v5, v31
    v_add_u32 v6, 128, v30
    v_and_b32 v6, 0xff, v6
    v_add_u32 v6, v6, v31
    v_add_u32 v7, 192, v30
    v_and_b32 v7, 0xff, v7
    v_add_u32 v7, v7, v31
    v_lshlrev_b32 v30, 2, v1
    v_add_u32 v8, 0, v30
    v_and_b32 v8, 0xff, v8
    v_add_u32 v8, s12, v8
    v_add_u32 v9, 16, v30
    v_and_b32 v9, 0xff, v9
    v_add_u32 v9, s12, v9
    v_add_u32 v10, 32, v30
    v_and_b32 v10, 0xff, v10
    v_add_u32 v10, s12, v10
    v_add_u32 v11, 48, v30
    v_and_b32 v11, 0xff, v11
    v_add_u32 v11, s12, v11
    v_add_u32 v12, 64, v30
    v_and_b32 v12, 0xff, v12
    v_add_u32 v12, s12, v12
    v_add_u32 v13, 80, v30
    v_and_b32 v13, 0xff, v13
    v_add_u32 v13, s12, v13
    v_add_u32 v14, 96, v30
    v_and_b32 v14, 0xff, v14
    v_add_u32 v14, s12, v14
    v_add_u32 v15, 112, v30
    v_and_b32 v15, 0xff, v15
    v_add_u32 v15, s12, v15
    v_add_u32 v16, 128, v30
    v_and_b32 v16, 0xff, v16
    v_add_u32 v16, s12, v16
    v_add_u32 v17, 144, v30
    v_and_b32 v17, 0xff, v17
    v_add_u32 v17, s12, v17
    v_add_u32 v18, 160, v30
    v_and_b32 v18, 0xff, v18
    v_add_u32 v18, s12, v18
    v_add_u32 v19, 176, v30
    v_and_b32 v19, 0xff, v19
    v_add_u32 v19, s12, v19
    v_add_u32 v20, 192, v30
    v_and_b32 v20, 0xff, v20
    v_add_u32 v20, s12, v20
    v_add_u32 v21, 208, v30
    v_and_b32 v21, 0xff, v21
    v_add_u32 v21, s12, v21
    v_add_u32 v22, 224, v30
    v_and_b32 v22, 0xff, v22
    v_add_u32 v22, s12, v22
    v_add_u32 v23, 240, v30
    v_and_b32 v23, 0xff, v23
    v_add_u32 v23, s12, v23
    s_waitcnt lgkmcnt(0)
    s_barrier
    s_lshl_b32 s8, s76, 16
    s_and_b32 s9, s76, 0xffff0000
    s_lshl_b32 s10, s77, 16
    s_and_b32 s11, s77, 0xffff0000
    s_cmp_eq_u32 s14, 0
    s_cselect_b32 s8, s8, s9
    s_cselect_b32 s77, s10, s11
    v_mov_b32 v28, s8
    v_mul_f32 v28, 1069066811, v28
    v_exp_f32 v28, v28
    s_nop 0
    v_cvt_pk_bf16_f32 v28, v28, v28
    v_and_b32 v28, 0xffff0000, v28
    v_add_f32 v29, v28, v28
    s_waitcnt vmcnt(0)
    v_lshlrev_b32 v24, 16, v24
    v_lshlrev_b32 v25, 16, v25
    v_lshlrev_b32 v26, 16, v26
    v_lshlrev_b32 v27, 16, v27
    v_mul_f32 v24, 1069066811, v24
    v_mul_f32 v25, v25, v28
    v_exp_f32 v24, v24
    v_mul_f32 v68, v26, v29
    v_mul_f32 v69, v27, v29
    v_mul_f32 v25, 0x3e22f983, v25
    v_cvt_pk_bf16_f32 v24, v24, v24
    v_mul_f32 v27, 0x43000000, v25
    v_and_b32 v24, 0xffff0000, v24
    v_fract_f32 v25, v25
    v_mul_f32 v24, v24, v28
    v_fract_f32 v27, v27
    v_mul_f32 v24, 0xbfb8aa3b, v24
    v_cos_f32 v34, v25
    v_mul_f32 v26, 0x43000000, v24
    v_sin_f32 v35, v25
    v_exp_f32 v24, v24
    v_cos_f32 v50, v27
    v_exp_f32 v26, v26
    v_sin_f32 v51, v27
    v_pk_mul_f32 v[34:35], v[34:35], v[24:25] op_sel_hi:[1,0]
    v_pk_mul_f32 v[50:51], v[50:51], v[26:27] op_sel_hi:[1,0]
    v_mov_b32 v80, 0x3f80
    v_pk_mul_f32 v[36:37], v[34:35], v[34:35] op_sel_hi:[0,1]
    v_pk_mul_f32 v[52:53], v[50:51], v[50:51] op_sel_hi:[0,1]
    v_cvt_pk_bf16_f32 v81, v34, v35
    v_cvt_pk_bf16_f32 v88, v50, v51
    v_cvt_pk_bf16_f32 v30, v68, -v69
    v_pk_fma_f32 v[36:37], v[34:35], v[34:35], v[36:37] op_sel:[1,1,0] op_sel_hi:[1,0,1] neg_lo:[1,0,0]
    v_pk_fma_f32 v[52:53], v[50:51], v[50:51], v[52:53] op_sel:[1,1,0] op_sel_hi:[1,0,1] neg_lo:[1,0,0]
    ds_write_b32 v8, v30 offset:0
    v_pk_mul_f32 v[40:41], v[36:37], v[36:37] op_sel_hi:[0,1]
    v_pk_mul_f32 v[38:39], v[36:37], v[34:35] op_sel_hi:[0,1]
    v_pk_mul_f32 v[54:55], v[52:53], v[50:51] op_sel_hi:[0,1]
    v_cvt_pk_bf16_f32 v82, v36, v37
    v_cvt_pk_bf16_f32 v96, v52, v53
    v_pk_fma_f32 v[40:41], v[36:37], v[36:37], v[40:41] op_sel:[1,1,0] op_sel_hi:[1,0,1] neg_lo:[1,0,0]
    v_pk_fma_f32 v[38:39], v[36:37], v[34:35], v[38:39] op_sel:[1,1,0] op_sel_hi:[1,0,1] neg_lo:[1,0,0]
    v_pk_fma_f32 v[54:55], v[52:53], v[50:51], v[54:55] op_sel:[1,1,0] op_sel_hi:[1,0,1] neg_lo:[1,0,0]
    v_pk_mul_f32 v[48:49], v[40:41], v[40:41] op_sel_hi:[0,1]
    v_pk_mul_f32 v[42:43], v[40:41], v[34:35] op_sel_hi:[0,1]
    v_pk_mul_f32 v[44:45], v[40:41], v[36:37] op_sel_hi:[0,1]
    v_pk_mul_f32 v[46:47], v[40:41], v[38:39] op_sel_hi:[0,1]
    v_pk_mul_f32 v[56:57], v[54:55], v[50:51] op_sel_hi:[0,1]
    v_cvt_pk_bf16_f32 v84, v40, v41
    v_cvt_pk_bf16_f32 v83, v38, v39
    v_cvt_pk_bf16_f32 v100, v54, v55
    v_pk_fma_f32 v[48:49], v[40:41], v[40:41], v[48:49] op_sel:[1,1,0] op_sel_hi:[1,0,1] neg_lo:[1,0,0]
    v_pk_fma_f32 v[42:43], v[40:41], v[34:35], v[42:43] op_sel:[1,1,0] op_sel_hi:[1,0,1] neg_lo:[1,0,0]
    v_pk_fma_f32 v[44:45], v[40:41], v[36:37], v[44:45] op_sel:[1,1,0] op_sel_hi:[1,0,1] neg_lo:[1,0,0]
    v_pk_fma_f32 v[46:47], v[40:41], v[38:39], v[46:47] op_sel:[1,1,0] op_sel_hi:[1,0,1] neg_lo:[1,0,0]
    v_pk_fma_f32 v[56:57], v[54:55], v[50:51], v[56:57] op_sel:[1,1,0] op_sel_hi:[1,0,1] neg_lo:[1,0,0]
    v_pk_mul_f32 v[70:71], v[68:69], v[48:49] op_sel_hi:[0,1]
    v_pk_mul_f32 v[58:59], v[56:57], v[50:51] op_sel_hi:[0,1]
    v_pk_mul_f32 v[72:73], v[50:51], v[34:35] op_sel_hi:[0,1]
    v_cvt_pk_bf16_f32 v85, v42, v43
    v_cvt_pk_bf16_f32 v86, v44, v45
    v_cvt_pk_bf16_f32 v87, v46, v47
    v_cvt_pk_bf16_f32 v104, v56, v57
    v_pk_fma_f32 v[70:71], v[68:69], v[48:49], v[70:71] op_sel:[1,1,0] op_sel_hi:[1,0,1] neg_lo:[1,0,0]
    v_pk_fma_f32 v[58:59], v[56:57], v[50:51], v[58:59] op_sel:[1,1,0] op_sel_hi:[1,0,1] neg_lo:[1,0,0]
    v_pk_fma_f32 v[72:73], v[50:51], v[34:35], v[72:73] op_sel:[1,1,0] op_sel_hi:[1,0,1] neg_lo:[1,0,0]
    v_pk_mul_f32 v[68:69], v[70:71], v[48:49] op_sel_hi:[0,1]
    v_pk_mul_f32 v[60:61], v[58:59], v[50:51] op_sel_hi:[0,1]
    v_pk_mul_f32 v[74:75], v[50:51], v[36:37] op_sel_hi:[0,1]
    v_cvt_pk_bf16_f32 v31, v70, -v71
    v_cvt_pk_bf16_f32 v106, v58, v59
    v_cvt_pk_bf16_f32 v89, v72, v73
    v_pk_fma_f32 v[68:69], v[70:71], v[48:49], v[68:69] op_sel:[1,1,0] op_sel_hi:[1,0,1] neg_lo:[1,0,0]
    v_pk_fma_f32 v[60:61], v[58:59], v[50:51], v[60:61] op_sel:[1,1,0] op_sel_hi:[1,0,1] neg_lo:[1,0,0]
    v_pk_fma_f32 v[74:75], v[50:51], v[36:37], v[74:75] op_sel:[1,1,0] op_sel_hi:[1,0,1] neg_lo:[1,0,0]
    ds_write_b32 v9, v31 offset:256
    v_pk_mul_f32 v[70:71], v[68:69], v[48:49] op_sel_hi:[0,1]
    v_pk_mul_f32 v[62:63], v[60:61], v[50:51] op_sel_hi:[0,1]
    v_pk_mul_f32 v[76:77], v[50:51], v[38:39] op_sel_hi:[0,1]
    v_cvt_pk_bf16_f32 v30, v68, -v69
    v_cvt_pk_bf16_f32 v108, v60, v61
    v_cvt_pk_bf16_f32 v90, v74, v75
    v_pk_fma_f32 v[70:71], v[68:69], v[48:49], v[70:71] op_sel:[1,1,0] op_sel_hi:[1,0,1] neg_lo:[1,0,0]
    v_pk_fma_f32 v[62:63], v[60:61], v[50:51], v[62:63] op_sel:[1,1,0] op_sel_hi:[1,0,1] neg_lo:[1,0,0]
    v_pk_fma_f32 v[76:77], v[50:51], v[38:39], v[76:77] op_sel:[1,1,0] op_sel_hi:[1,0,1] neg_lo:[1,0,0]
    ds_write_b32 v10, v30 offset:512
    v_pk_mul_f32 v[68:69], v[70:71], v[48:49] op_sel_hi:[0,1]
    v_pk_mul_f32 v[64:65], v[62:63], v[50:51] op_sel_hi:[0,1]
    v_pk_mul_f32 v[78:79], v[50:51], v[40:41] op_sel_hi:[0,1]
    v_cvt_pk_bf16_f32 v31, v70, -v71
    v_cvt_pk_bf16_f32 v110, v62, v63
    v_cvt_pk_bf16_f32 v91, v76, v77
    v_pk_fma_f32 v[68:69], v[70:71], v[48:49], v[68:69] op_sel:[1,1,0] op_sel_hi:[1,0,1] neg_lo:[1,0,0]
    v_pk_fma_f32 v[64:65], v[62:63], v[50:51], v[64:65] op_sel:[1,1,0] op_sel_hi:[1,0,1] neg_lo:[1,0,0]
    v_pk_fma_f32 v[78:79], v[50:51], v[40:41], v[78:79] op_sel:[1,1,0] op_sel_hi:[1,0,1] neg_lo:[1,0,0]
    ds_write_b32 v11, v31 offset:768
    v_pk_mul_f32 v[70:71], v[68:69], v[48:49] op_sel_hi:[0,1]
    v_pk_mul_f32 v[66:67], v[64:65], v[50:51] op_sel_hi:[0,1]
    v_pk_mul_f32 v[72:73], v[50:51], v[42:43] op_sel_hi:[0,1]
    v_cvt_pk_bf16_f32 v30, v68, -v69
    v_cvt_pk_bf16_f32 v112, v64, v65
    v_cvt_pk_bf16_f32 v92, v78, v79
    v_pk_fma_f32 v[70:71], v[68:69], v[48:49], v[70:71] op_sel:[1,1,0] op_sel_hi:[1,0,1] neg_lo:[1,0,0]
    v_pk_fma_f32 v[66:67], v[64:65], v[50:51], v[66:67] op_sel:[1,1,0] op_sel_hi:[1,0,1] neg_lo:[1,0,0]
    v_pk_fma_f32 v[72:73], v[50:51], v[42:43], v[72:73] op_sel:[1,1,0] op_sel_hi:[1,0,1] neg_lo:[1,0,0]
    ds_write_b32 v12, v30 offset:1024
    v_pk_mul_f32 v[68:69], v[70:71], v[48:49] op_sel_hi:[0,1]
    v_pk_mul_f32 v[64:65], v[66:67], v[50:51] op_sel_hi:[0,1]
    v_pk_mul_f32 v[74:75], v[50:51], v[44:45] op_sel_hi:[0,1]
    v_cvt_pk_bf16_f32 v31, v70, -v71
    v_cvt_pk_bf16_f32 v113, v66, v67
    v_cvt_pk_bf16_f32 v93, v72, v73
    v_pk_fma_f32 v[68:69], v[70:71], v[48:49], v[68:69] op_sel:[1,1,0] op_sel_hi:[1,0,1] neg_lo:[1,0,0]
    v_pk_fma_f32 v[64:65], v[66:67], v[50:51], v[64:65] op_sel:[1,1,0] op_sel_hi:[1,0,1] neg_lo:[1,0,0]
    v_pk_fma_f32 v[74:75], v[50:51], v[44:45], v[74:75] op_sel:[1,1,0] op_sel_hi:[1,0,1] neg_lo:[1,0,0]
    ds_write_b32 v13, v31 offset:1280
    v_pk_mul_f32 v[70:71], v[68:69], v[48:49] op_sel_hi:[0,1]
    v_pk_mul_f32 v[66:67], v[64:65], v[50:51] op_sel_hi:[0,1]
    v_pk_mul_f32 v[76:77], v[50:51], v[46:47] op_sel_hi:[0,1]
    v_cvt_pk_bf16_f32 v30, v68, -v69
    v_cvt_pk_bf16_f32 v114, v64, v65
    v_cvt_pk_bf16_f32 v94, v74, v75
    v_pk_fma_f32 v[70:71], v[68:69], v[48:49], v[70:71] op_sel:[1,1,0] op_sel_hi:[1,0,1] neg_lo:[1,0,0]
    v_pk_fma_f32 v[66:67], v[64:65], v[50:51], v[66:67] op_sel:[1,1,0] op_sel_hi:[1,0,1] neg_lo:[1,0,0]
    v_pk_fma_f32 v[76:77], v[50:51], v[46:47], v[76:77] op_sel:[1,1,0] op_sel_hi:[1,0,1] neg_lo:[1,0,0]
    ds_write_b32 v14, v30 offset:1536
    v_pk_mul_f32 v[68:69], v[70:71], v[48:49] op_sel_hi:[0,1]
    v_pk_mul_f32 v[64:65], v[66:67], v[50:51] op_sel_hi:[0,1]
    v_pk_mul_f32 v[78:79], v[52:53], v[36:37] op_sel_hi:[0,1]
    v_cvt_pk_bf16_f32 v31, v70, -v71
    v_cvt_pk_bf16_f32 v115, v66, v67
    v_cvt_pk_bf16_f32 v95, v76, v77
    v_pk_fma_f32 v[68:69], v[70:71], v[48:49], v[68:69] op_sel:[1,1,0] op_sel_hi:[1,0,1] neg_lo:[1,0,0]
    v_pk_fma_f32 v[64:65], v[66:67], v[50:51], v[64:65] op_sel:[1,1,0] op_sel_hi:[1,0,1] neg_lo:[1,0,0]
    v_pk_fma_f32 v[78:79], v[52:53], v[36:37], v[78:79] op_sel:[1,1,0] op_sel_hi:[1,0,1] neg_lo:[1,0,0]
    ds_write_b32 v15, v31 offset:1792
    v_pk_mul_f32 v[70:71], v[68:69], v[48:49] op_sel_hi:[0,1]
    v_pk_mul_f32 v[66:67], v[64:65], v[50:51] op_sel_hi:[0,1]
    v_pk_mul_f32 v[72:73], v[52:53], v[40:41] op_sel_hi:[0,1]
    v_cvt_pk_bf16_f32 v30, v68, -v69
    v_cvt_pk_bf16_f32 v116, v64, v65
    v_cvt_pk_bf16_f32 v97, v78, v79
    v_pk_fma_f32 v[70:71], v[68:69], v[48:49], v[70:71] op_sel:[1,1,0] op_sel_hi:[1,0,1] neg_lo:[1,0,0]
    v_pk_fma_f32 v[66:67], v[64:65], v[50:51], v[66:67] op_sel:[1,1,0] op_sel_hi:[1,0,1] neg_lo:[1,0,0]
    v_pk_fma_f32 v[72:73], v[52:53], v[40:41], v[72:73] op_sel:[1,1,0] op_sel_hi:[1,0,1] neg_lo:[1,0,0]
    ds_write_b32 v16, v30 offset:2048
    v_pk_mul_f32 v[68:69], v[70:71], v[48:49] op_sel_hi:[0,1]
    v_pk_mul_f32 v[64:65], v[66:67], v[50:51] op_sel_hi:[0,1]
    v_pk_mul_f32 v[74:75], v[52:53], v[44:45] op_sel_hi:[0,1]
    v_cvt_pk_bf16_f32 v31, v70, -v71
    v_cvt_pk_bf16_f32 v117, v66, v67
    v_cvt_pk_bf16_f32 v98, v72, v73
    v_pk_fma_f32 v[68:69], v[70:71], v[48:49], v[68:69] op_sel:[1,1,0] op_sel_hi:[1,0,1] neg_lo:[1,0,0]
    v_pk_fma_f32 v[64:65], v[66:67], v[50:51], v[64:65] op_sel:[1,1,0] op_sel_hi:[1,0,1] neg_lo:[1,0,0]
    v_pk_fma_f32 v[74:75], v[52:53], v[44:45], v[74:75] op_sel:[1,1,0] op_sel_hi:[1,0,1] neg_lo:[1,0,0]
    ds_write_b32 v17, v31 offset:2304
    v_pk_mul_f32 v[70:71], v[68:69], v[48:49] op_sel_hi:[0,1]
    v_pk_mul_f32 v[66:67], v[64:65], v[50:51] op_sel_hi:[0,1]
    v_pk_mul_f32 v[76:77], v[54:55], v[36:37] op_sel_hi:[0,1]
    v_cvt_pk_bf16_f32 v30, v68, -v69
    v_cvt_pk_bf16_f32 v118, v64, v65
    v_cvt_pk_bf16_f32 v99, v74, v75
    v_pk_fma_f32 v[70:71], v[68:69], v[48:49], v[70:71] op_sel:[1,1,0] op_sel_hi:[1,0,1] neg_lo:[1,0,0]
    v_pk_fma_f32 v[66:67], v[64:65], v[50:51], v[66:67] op_sel:[1,1,0] op_sel_hi:[1,0,1] neg_lo:[1,0,0]
    v_pk_fma_f32 v[76:77], v[54:55], v[36:37], v[76:77] op_sel:[1,1,0] op_sel_hi:[1,0,1] neg_lo:[1,0,0]
    ds_write_b32 v18, v30 offset:2560
    v_pk_mul_f32 v[68:69], v[70:71], v[48:49] op_sel_hi:[0,1]
    v_pk_mul_f32 v[64:65], v[66:67], v[50:51] op_sel_hi:[0,1]
    v_pk_mul_f32 v[78:79], v[54:55], v[40:41] op_sel_hi:[0,1]
    v_cvt_pk_bf16_f32 v31, v70, -v71
    v_cvt_pk_bf16_f32 v119, v66, v67
    v_cvt_pk_bf16_f32 v101, v76, v77
    v_pk_fma_f32 v[68:69], v[70:71], v[48:49], v[68:69] op_sel:[1,1,0] op_sel_hi:[1,0,1] neg_lo:[1,0,0]
    v_pk_fma_f32 v[64:65], v[66:67], v[50:51], v[64:65] op_sel:[1,1,0] op_sel_hi:[1,0,1] neg_lo:[1,0,0]
    v_pk_fma_f32 v[78:79], v[54:55], v[40:41], v[78:79] op_sel:[1,1,0] op_sel_hi:[1,0,1] neg_lo:[1,0,0]
    ds_write_b32 v19, v31 offset:2816
    v_pk_mul_f32 v[70:71], v[68:69], v[48:49] op_sel_hi:[0,1]
    v_pk_mul_f32 v[72:73], v[54:55], v[44:45] op_sel_hi:[0,1]
    v_pk_mul_f32 v[74:75], v[56:57], v[40:41] op_sel_hi:[0,1]
    v_cvt_pk_bf16_f32 v30, v68, -v69
    v_cvt_pk_bf16_f32 v120, v64, v65
    v_cvt_pk_bf16_f32 v102, v78, v79
    v_pk_fma_f32 v[70:71], v[68:69], v[48:49], v[70:71] op_sel:[1,1,0] op_sel_hi:[1,0,1] neg_lo:[1,0,0]
    v_pk_fma_f32 v[72:73], v[54:55], v[44:45], v[72:73] op_sel:[1,1,0] op_sel_hi:[1,0,1] neg_lo:[1,0,0]
    v_pk_fma_f32 v[74:75], v[56:57], v[40:41], v[74:75] op_sel:[1,1,0] op_sel_hi:[1,0,1] neg_lo:[1,0,0]
    ds_write_b32 v20, v30 offset:3072
    v_pk_mul_f32 v[68:69], v[70:71], v[48:49] op_sel_hi:[0,1]
    v_pk_mul_f32 v[76:77], v[58:59], v[40:41] op_sel_hi:[0,1]
    v_pk_mul_f32 v[78:79], v[60:61], v[40:41] op_sel_hi:[0,1]
    v_cvt_pk_bf16_f32 v31, v70, -v71
    v_cvt_pk_bf16_f32 v103, v72, v73
    v_cvt_pk_bf16_f32 v105, v74, v75
    v_pk_fma_f32 v[68:69], v[70:71], v[48:49], v[68:69] op_sel:[1,1,0] op_sel_hi:[1,0,1] neg_lo:[1,0,0]
    v_pk_fma_f32 v[76:77], v[58:59], v[40:41], v[76:77] op_sel:[1,1,0] op_sel_hi:[1,0,1] neg_lo:[1,0,0]
    v_pk_fma_f32 v[78:79], v[60:61], v[40:41], v[78:79] op_sel:[1,1,0] op_sel_hi:[1,0,1] neg_lo:[1,0,0]
    ds_write_b32 v21, v31 offset:3328
    v_pk_mul_f32 v[70:71], v[68:69], v[48:49] op_sel_hi:[0,1]
    v_pk_mul_f32 v[72:73], v[62:63], v[40:41] op_sel_hi:[0,1]
    v_cvt_pk_bf16_f32 v30, v68, -v69
    v_cvt_pk_bf16_f32 v107, v76, v77
    v_cvt_pk_bf16_f32 v109, v78, v79
    v_pk_fma_f32 v[70:71], v[68:69], v[48:49], v[70:71] op_sel:[1,1,0] op_sel_hi:[1,0,1] neg_lo:[1,0,0]
    v_pk_fma_f32 v[72:73], v[62:63], v[40:41], v[72:73] op_sel:[1,1,0] op_sel_hi:[1,0,1] neg_lo:[1,0,0]
    ds_write_b32 v22, v30 offset:3584
    v_cvt_pk_bf16_f32 v31, v70, -v71
    v_cvt_pk_bf16_f32 v111, v72, v73
    ds_write_b32 v23, v31 offset:3840
    ds_read_b128 v[32:35], v4
    ds_read_b128 v[36:39], v5
    ds_read_b128 v[40:43], v6
    ds_read_b128 v[44:47], v7
    ds_write_b32 v8, v80 offset:0
    ds_write_b32 v9, v81 offset:256
    ds_write_b32 v10, v82 offset:512
    ds_write_b32 v11, v83 offset:768
    ds_write_b32 v12, v84 offset:1024
    ds_write_b32 v13, v85 offset:1280
    ds_write_b32 v14, v86 offset:1536
    ds_write_b32 v15, v87 offset:1792
    ds_write_b32 v16, v88 offset:2048
    ds_write_b32 v17, v89 offset:2304
    ds_write_b32 v18, v90 offset:2560
    ds_write_b32 v19, v91 offset:2816
    ds_write_b32 v20, v92 offset:3072
    ds_write_b32 v21, v93 offset:3328
    ds_write_b32 v22, v94 offset:3584
    ds_write_b32 v23, v95 offset:3840
    ds_read_b128 v[48:51], v4
    ds_read_b128 v[52:55], v5
    ds_read_b128 v[56:59], v6
    ds_read_b128 v[60:63], v7
    ds_write_b32 v8, v96 offset:0
    ds_write_b32 v9, v97 offset:256
    ds_write_b32 v10, v98 offset:512
    ds_write_b32 v11, v99 offset:768
    ds_write_b32 v12, v100 offset:1024
    ds_write_b32 v13, v101 offset:1280
    ds_write_b32 v14, v102 offset:1536
    ds_write_b32 v15, v103 offset:1792
    ds_write_b32 v16, v104 offset:2048
    ds_write_b32 v17, v105 offset:2304
    ds_write_b32 v18, v106 offset:2560
    ds_write_b32 v19, v107 offset:2816
    ds_write_b32 v20, v108 offset:3072
    ds_write_b32 v21, v109 offset:3328
    ds_write_b32 v22, v110 offset:3584
    ds_write_b32 v23, v111 offset:3840
    ds_read_b128 v[64:67], v4
    ds_read_b128 v[68:71], v5
    ds_read_b128 v[72:75], v6
    ds_read_b128 v[76:79], v7
    ds_write_b32 v8, v112 offset:0
    ds_write_b32 v9, v113 offset:256
    ds_write_b32 v10, v114 offset:512
    ds_write_b32 v11, v115 offset:768
    ds_write_b32 v12, v116 offset:1024
    ds_write_b32 v13, v117 offset:1280
    ds_write_b32 v14, v118 offset:1536
    ds_write_b32 v15, v119 offset:1792
    ds_write_b32 v16, v120 offset:2048
    ds_read_b128 v[128:131], v4
    ds_read_b128 v[132:135], v5
    ds_read_b128 v[136:139], v6
    ds_read_b128 v[140:143], v7
    s_waitcnt lgkmcnt(14)
    v_mfma_f32_16x16x32_bf16 v[144:147], v[48:51], v[32:35], 0
    v_mfma_f32_16x16x32_bf16 v[144:147], v[52:55], v[36:39], v[144:147]
    v_mfma_f32_16x16x32_bf16 v[144:147], v[56:59], v[40:43], v[144:147]
    v_mfma_f32_16x16x32_bf16 v[144:147], v[60:63], v[44:47], v[144:147]
    s_waitcnt lgkmcnt(13)
    v_mfma_f32_16x16x32_bf16 v[148:151], v[64:67], v[32:35], 0
    v_mfma_f32_16x16x32_bf16 v[148:151], v[68:71], v[36:39], v[148:151]
    v_mfma_f32_16x16x32_bf16 v[148:151], v[72:75], v[40:43], v[148:151]
    v_mfma_f32_16x16x32_bf16 v[148:151], v[76:79], v[44:47], v[148:151]
    s_waitcnt lgkmcnt(0)
    v_mfma_f32_16x16x32_bf16 v[152:155], v[128:131], v[32:35], 0
    v_mfma_f32_16x16x32_bf16 v[152:155], v[132:135], v[36:39], v[152:155]
    v_mfma_f32_16x16x32_bf16 v[152:155], v[136:139], v[40:43], v[152:155]
    v_mfma_f32_16x16x32_bf16 v[152:155], v[140:143], v[44:47], v[152:155]
    s_add_u32 s8, s13, 4096
    v_lshl_add_u32 v28, v1, 4, s8
    s_lshl_b32 s8, s14, 2
    v_add_u32 v29, s8, v2
    s_cmp_eq_u32 s15, 0
    s_cbranch_scc1 L_Kfin
    ds_write_b128 v28, v[144:147] offset:0
    ds_write_b128 v28, v[148:151] offset:1024
    ds_write_b128 v28, v[152:155] offset:2048
    v_mov_b32 v30, 1
    ds_write_b32 v29, v30 offset:96
    s_branch L_conv
L_Kfin:
    v_and_b32 v12, 15, v1
    v_lshrrev_b32 v13, 4, v1
    s_add_u32 s12, s13, 64
    v_lshrrev_b32 v14, 1, v13
    v_lshlrev_b32 v14, 7, v14
    v_and_b32 v15, 1, v13
    v_lshl_add_u32 v14, v15, 2, v14
    v_lshl_add_u32 v14, v12, 3, v14
    v_lshl_add_u32 v14, v14, 2, s12
    v_cmp_gt_u32 vcc, 2, v13
    v_lshlrev_b32 v15, 1, v12
    v_lshlrev_b32 v16, 2, v12
    v_cndmask_b32 v15, v15, v16, vcc
    v_lshl_add_u32 v15, v13, 6, v15
    v_lshl_add_u32 v15, v15, 2, s12
    v_mov_b32 v16, 128
    v_cndmask_b32 v16, v16, 8, vcc
    v_add_u32 v16, v16, v15
    v_lshl_add_u32 v17, v13, 6, v12
    v_lshl_add_u32 v17, v17, 2, s12
    v_lshl_add_u32 v18, v1, 3, s12
    v_lshl_add_u32 v19, v1, 4, s13
    v_cmp_eq_u32 vcc, 0, v1
    v_add_u32 v20, 4, v18
    s_nop 0
    v_cndmask_b32 v20, v20, v18, vcc
    v_mov_b32 v21, 0
    v_mov_b32 v22, s13
    v_sub_u32 v23, 63, v1
    v_lshl_add_u32 v24, v23, 5, s13
    v_lshl_add_u32 v25, v23, 4, s13
    v_lshl_add_u32 v26, v23, 3, s13
    v_and_b32 v27, 7, v1
    v_lshl_add_u32 v27, v27, 2, s13
    s_mov_b32 s5, 0x8000
Lp49:
    ds_read_b32 v30, v29 offset:96
    s_waitcnt lgkmcnt(0)
    v_readfirstlane_b32 s4, v30
    s_nop 0
    s_cmp_ge_u32 s4, 1
    s_cbranch_scc1 Lpe50
    s_sub_u32 s5, s5, 1
    s_cmp_lg_u32 s5, 0
    s_cbranch_scc1 Lp49
Lpe50:
    ds_read_b128 v[32:35], v28 offset:0
    ds_read_b128 v[36:39], v28 offset:1024
    ds_read_b128 v[40:43], v28 offset:2048
    s_waitcnt lgkmcnt(0)
    v_add_f32 v144, v144, v32
    v_add_f32 v145, v145, v33
    v_add_f32 v146, v146, v34
    v_add_f32 v147, v147, v35
    v_add_f32 v148, v148, v36
    v_add_f32 v149, v149, v37
    v_add_f32 v150, v150, v38
    v_add_f32 v151, v151, v39
    v_add_f32 v152, v152, v40
    v_add_f32 v153, v153, v41
    v_add_f32 v154, v154, v42
    v_add_f32 v155, v155, v43
    ds_write_b32 v22, v21 offset:60
    ds_write_b128 v14, v[144:147]
    ds_write_b64 v15, v[148:149] offset:1024
    ds_write_b64 v16, v[150:151] offset:1024
    ds_write_b32 v17, v152 offset:2048
    ds_write_b32 v17, v153 offset:2112
    ds_write_b32 v17, v154 offset:2176
    ds_write_b32 v17, v155 offset:2240
    ds_read_b64 v[32:33], v18 offset:2048
    ds_read_b32 v34, v18 offset:2056
    ds_read_b64 v[36:37], v18 offset:1536
    ds_read_b32 v38, v18 offset:1544
    ds_read_b64 v[40:41], v18 offset:1024
    ds_read_b32 v42, v18 offset:1032
    ds_read_b32 v43, v20 offset:1020
    ds_read_b128 v[44:47], v19 offset:64
    ds_read_b32 v48, v19 offset:60
    s_waitcnt lgkmcnt(0)
    v_cvt_pk_bf16_f32 v100, v34, v34
    v_cvt_pk_bf16_f32 v101, v34, v34
    v_cvt_pk_bf16_f32 v102, v33, v33
    v_cvt_pk_bf16_f32 v103, v33, v33
    v_cvt_pk_bf16_f32 v104, v33, v33
    v_cvt_pk_bf16_f32 v105, v33, v32
    v_cvt_pk_bf16_f32 v106, v32, v32
    v_cvt_pk_bf16_f32 v107, v32, v32
    v_cvt_pk_bf16_f32 v108, v34, v34
    v_cvt_pk_bf16_f32 v109, v34, v33
    v_cvt_pk_bf16_f32 v110, v33, v33
    v_cvt_pk_bf16_f32 v111, v33, v33
    v_cvt_pk_bf16_f32 v112, v33, v33
    v_cvt_pk_bf16_f32 v113, v32, v32
    v_cvt_pk_bf16_f32 v114, v32, v32
    v_cvt_pk_bf16_f32 v115, v32, v32
    ds_write_b128 v24, v[100:103]
    ds_write_b128 v24, v[104:107] offset:16
    ds_write_b128 v24, v[108:111] offset:4160
    ds_write_b128 v24, v[112:115] offset:4176
    v_cvt_pk_bf16_f32 v116, v38, v38
    v_cvt_pk_bf16_f32 v117, v37, v37
    v_cvt_pk_bf16_f32 v118, v37, v36
    v_cvt_pk_bf16_f32 v119, v36, v36
    v_cvt_pk_bf16_f32 v120, v38, v37
    v_cvt_pk_bf16_f32 v121, v37, v37
    v_cvt_pk_bf16_f32 v122, v36, v36
    v_cvt_pk_bf16_f32 v123, v36, v36
    ds_write_b128 v25, v[116:119] offset:2048
    ds_write_b128 v25, v[120:123] offset:6208
    v_cvt_pk_bf16_f32 v124, v42, v41
    v_cvt_pk_bf16_f32 v125, v40, v40
    v_cvt_pk_bf16_f32 v126, v41, v40
    v_cvt_pk_bf16_f32 v127, v40, v43
    ds_write_b64 v26, v[124:125] offset:3072
    ds_write_b64 v26, v[126:127] offset:7232
    v_cvt_pk_bf16_f32 v128, v47, v46
    v_cvt_pk_bf16_f32 v129, v45, v44
    v_cvt_pk_bf16_f32 v130, v46, v45
    v_cvt_pk_bf16_f32 v131, v44, v48
    ds_write_b64 v26, v[128:129] offset:3584
    ds_write_b64 v26, v[130:131] offset:7744
    ds_write_b32 v27, v21 offset:4096
    ds_write_b32 v27, v21 offset:8256
    v_mov_b32 v24, 1
    ds_write_b32 v29, v24 offset:40
L_conv:
    s_mul_i32 s12, s14, 4608
    s_add_u32 s12, s12, 152064
    s_lshl_b32 s10, s15, 8
    v_and_b32 v3, 15, v1
    v_lshrrev_b32 v4, 4, v1
    v_lshrrev_b32 v5, 1, v3
    v_lshl_add_u32 v5, v4, 2, v5
    v_lshlrev_b32 v5, 2, v5
    v_and_b32 v6, 1, v3
    v_mul_u32_u24 v6, 4160, v6
    v_add_u32 v5, v5, v6
    s_add_u32 s8, s13, 7564
    s_sub_u32 s8, s8, s10
    v_sub_u32 v8, s8, v5
    v_subrev_u32 v9, 1024, v8
    v_subrev_u32 v10, 2048, v8
    v_subrev_u32 v11, 3072, v8
    v_lshlrev_b32 v5, 5, v3
    v_lshlrev_b32 v6, 4, v4
    v_sub_u32 v6, v5, v6
    s_add_u32 s8, s12, 336
    s_sub_u32 s8, s8, s10
    v_add_u32 v12, s8, v6
    s_lshl_b32 s8, s3, 2
    v_add_u32 v14, s8, v2
    s_xor_b32 s8, s8, 8
    v_add_u32 v15, s8, v2
    v_lshl_add_u32 v5, v4, 3, v5
    v_add_u32 v16, s12, v5
    s_lshl_b32 s8, s15, 12
    s_add_u32 s8, s8, s13
    v_lshl_add_u32 v17, v1, 4, s8
    s_xor_b32 s9, s15, 1
    s_lshl_b32 s9, s9, 12
    s_add_u32 s9, s9, s13
    v_lshl_add_u32 v18, v1, 4, s9
    v_add_u32 v19, s9, v5
    s_lshl_b32 s6, s75, 1
    s_add_u32 s6, s6, s14
    s_lshl_b32 s8, s15, 9
    s_add_u32 s7, s6, s8
    s_lshl_b32 s7, s7, 7
    s_add_u32 s7, s7, 655360
    s_lshl_b32 s6, s6, 12
    s_lshl_b32 s8, s15, 11
    s_add_u32 s6, s6, s8
    s_add_u32 s6, s6, 14680064
    v_lshlrev_b32 v6, 4, v1
    s_add_u32 s8, s68, 1
    v_mov_b32 v24, s8
    v_mov_b32 v25, 0
    v_mov_b32 v26, 1
    s_cmp_eq_u32 s15, 0
    s_cselect_b32 s10, s77, 0
    s_cselect_b32 s11, 0, s77
    s_mov_b32 s5, 0x8000
Lp51:
    ds_read_b32 v20, v29 offset:40
    s_waitcnt lgkmcnt(0)
    v_readfirstlane_b32 s4, v20
    s_nop 0
    s_cmp_ge_u32 s4, 1
    s_cbranch_scc1 Lpe52
    s_sleep 4
    s_sub_u32 s5, s5, 1
    s_cmp_lg_u32 s5, 0
    s_cbranch_scc1 Lp51
Lpe52:
    s_mov_b32 s5, 0x8000
Lp53:
    ds_read_b32 v20, v2 offset:36
    s_waitcnt lgkmcnt(0)
    v_readfirstlane_b32 s4, v20
    s_nop 0
    s_cmp_ge_u32 s4, 1
    s_cbranch_scc1 Lpe54
    s_sleep 4
    s_sub_u32 s5, s5, 1
    s_cmp_lg_u32 s5, 0
    s_cbranch_scc1 Lp53
Lpe54:
    ds_read_b64 v[128:129], v16 offset:512
    ds_read_b64 v[130:131], v16 offset:1024
    ds_read_b64 v[132:133], v16 offset:1536
    ds_read_b64 v[134:135], v16 offset:2048
    ds_read_b64 v[136:137], v16 offset:2560
    ds_read_b64 v[138:139], v16 offset:3072
    ds_read_b64 v[140:141], v16 offset:3584
    ds_read_b64 v[142:143], v16 offset:4096
    s_waitcnt lgkmcnt(0)
    ds_read2_b32 v[64:65], v8 offset0:176 offset1:177
    ds_read2_b32 v[66:67], v8 offset0:178 offset1:179
    ds_read_b128 v[96:99], v12 offset:192
    ds_read2_b32 v[68:69], v8 offset0:48 offset1:49
    ds_read2_b32 v[70:71], v8 offset0:50 offset1:51
    ds_read_b128 v[100:103], v12 offset:704
    ds_read2_b32 v[72:73], v9 offset0:176 offset1:177
    ds_read2_b32 v[74:75], v9 offset0:178 offset1:179
    ds_read_b128 v[104:107], v12 offset:1216
    ds_read2_b32 v[76:77], v9 offset0:48 offset1:49
    ds_read2_b32 v[78:79], v9 offset0:50 offset1:51
    ds_read_b128 v[108:111], v12 offset:1728
    ds_read2_b32 v[80:81], v10 offset0:176 offset1:177
    ds_read2_b32 v[82:83], v10 offset0:178 offset1:179
    ds_read_b128 v[112:115], v12 offset:2240
    ds_read2_b32 v[84:85], v10 offset0:48 offset1:49
    ds_read2_b32 v[86:87], v10 offset0:50 offset1:51
    ds_read_b128 v[116:119], v12 offset:2752
    ds_read2_b32 v[88:89], v11 offset0:176 offset1:177
    ds_read2_b32 v[90:91], v11 offset0:178 offset1:179
    ds_read_b128 v[120:123], v12 offset:3264
    ds_read2_b32 v[92:93], v11 offset0:48 offset1:49
    ds_read2_b32 v[94:95], v11 offset0:50 offset1:51
    ds_read_b128 v[124:127], v12 offset:3776
    v_lshlrev_b32 v32, 16, v128
    v_and_b32 v33, 0xffff0000, v128
    v_lshlrev_b32 v34, 16, v129
    v_and_b32 v35, 0xffff0000, v129
    v_lshlrev_b32 v36, 16, v130
    v_and_b32 v37, 0xffff0000, v130
    v_lshlrev_b32 v38, 16, v131
    v_and_b32 v39, 0xffff0000, v131
    v_lshlrev_b32 v40, 16, v132
    v_and_b32 v41, 0xffff0000, v132
    v_lshlrev_b32 v42, 16, v133
    v_and_b32 v43, 0xffff0000, v133
    v_lshlrev_b32 v44, 16, v134
    v_and_b32 v45, 0xffff0000, v134
    v_lshlrev_b32 v46, 16, v135
    v_and_b32 v47, 0xffff0000, v135
    v_lshlrev_b32 v48, 16, v136
    v_and_b32 v49, 0xffff0000, v136
    v_lshlrev_b32 v50, 16, v137
    v_and_b32 v51, 0xffff0000, v137
    v_lshlrev_b32 v52, 16, v138
    v_and_b32 v53, 0xffff0000, v138
    v_lshlrev_b32 v54, 16, v139
    v_and_b32 v55, 0xffff0000, v139
    v_lshlrev_b32 v56, 16, v140
    v_and_b32 v57, 0xffff0000, v140
    v_lshlrev_b32 v58, 16, v141
    v_and_b32 v59, 0xffff0000, v141
    v_lshlrev_b32 v60, 16, v142
    v_and_b32 v61, 0xffff0000, v142
    v_lshlrev_b32 v62, 16, v143
    v_and_b32 v63, 0xffff0000, v143
    v_mul_f32 v32, s10, v32
    v_mul_f32 v33, s10, v33
    v_mul_f32 v34, s10, v34
    v_mul_f32 v35, s10, v35
    v_mul_f32 v36, s10, v36
    v_mul_f32 v37, s10, v37
    v_mul_f32 v38, s10, v38
    v_mul_f32 v39, s10, v39
    v_mul_f32 v40, s10, v40
    v_mul_f32 v41, s10, v41
    v_mul_f32 v42, s10, v42
    v_mul_f32 v43, s10, v43
    v_mul_f32 v44, s10, v44
    v_mul_f32 v45, s10, v45
    v_mul_f32 v46, s10, v46
    v_mul_f32 v47, s10, v47
    v_mul_f32 v48, s11, v48
    v_mul_f32 v49, s11, v49
    v_mul_f32 v50, s11, v50
    v_mul_f32 v51, s11, v51
    v_mul_f32 v52, s11, v52
    v_mul_f32 v53, s11, v53
    v_mul_f32 v54, s11, v54
    v_mul_f32 v55, s11, v55
    v_mul_f32 v56, s11, v56
    v_mul_f32 v57, s11, v57
    v_mul_f32 v58, s11, v58
    v_mul_f32 v59, s11, v59
    v_mul_f32 v60, s11, v60
    v_mul_f32 v61, s11, v61
    v_mul_f32 v62, s11, v62
    v_mul_f32 v63, s11, v63
    s_mov_b32 s5, 0x8000
Lp55:
    ds_read_b128 v[20:23], v2 offset:16
    s_waitcnt lgkmcnt(0)
    v_min3_u32 v20, v20, v21, v22
    v_min_u32 v20, v20, v23
    s_nop 0
    v_readfirstlane_b32 s4, v20
    s_nop 0
    s_cmp_ge_u32 s4, 9
    s_cbranch_scc1 Lpe56
    s_sleep 1
    s_sub_u32 s5, s5, 1
    s_cmp_lg_u32 s5, 0
    s_cbranch_scc1 Lp55
Lpe56:
    s_setprio 1
    v_mfma_f32_16x16x32_bf16 v[60:63], v[64:67], v[124:127], v[60:63]
    ds_read_b128 v[124:127], v12 offset:3712
    v_mfma_f32_16x16x32_bf16 v[56:59], v[64:67], v[120:123], v[56:59]
    v_mfma_f32_16x16x32_bf16 v[52:55], v[64:67], v[116:119], v[52:55]
    v_mfma_f32_16x16x32_bf16 v[48:51], v[64:67], v[112:115], v[48:51]
    v_mfma_f32_16x16x32_bf16 v[44:47], v[64:67], v[108:111], v[44:47]
    v_mfma_f32_16x16x32_bf16 v[40:43], v[64:67], v[104:107], v[40:43]
    v_mfma_f32_16x16x32_bf16 v[36:39], v[64:67], v[100:103], v[36:39]
    v_mfma_f32_16x16x32_bf16 v[32:35], v[64:67], v[96:99], v[32:35]
    ds_read2_b32 v[64:65], v8 offset0:160 offset1:161
    ds_read2_b32 v[66:67], v8 offset0:162 offset1:163
    v_mfma_f32_16x16x32_bf16 v[60:63], v[68:71], v[120:123], v[60:63]
    ds_read_b128 v[120:123], v12 offset:3200
    v_mfma_f32_16x16x32_bf16 v[56:59], v[68:71], v[116:119], v[56:59]
    v_mfma_f32_16x16x32_bf16 v[52:55], v[68:71], v[112:115], v[52:55]
    v_mfma_f32_16x16x32_bf16 v[48:51], v[68:71], v[108:111], v[48:51]
    v_mfma_f32_16x16x32_bf16 v[44:47], v[68:71], v[104:107], v[44:47]
    v_mfma_f32_16x16x32_bf16 v[40:43], v[68:71], v[100:103], v[40:43]
    v_mfma_f32_16x16x32_bf16 v[36:39], v[68:71], v[96:99], v[36:39]
    ds_read2_b32 v[68:69], v8 offset0:32 offset1:33
    ds_read2_b32 v[70:71], v8 offset0:34 offset1:35
    v_mfma_f32_16x16x32_bf16 v[60:63], v[72:75], v[116:119], v[60:63]
    ds_read_b128 v[116:119], v12 offset:2688
    v_mfma_f32_16x16x32_bf16 v[56:59], v[72:75], v[112:115], v[56:59]
    v_mfma_f32_16x16x32_bf16 v[52:55], v[72:75], v[108:111], v[52:55]
    v_mfma_f32_16x16x32_bf16 v[48:51], v[72:75], v[104:107], v[48:51]
    v_mfma_f32_16x16x32_bf16 v[44:47], v[72:75], v[100:103], v[44:47]
    v_mfma_f32_16x16x32_bf16 v[40:43], v[72:75], v[96:99], v[40:43]
    ds_read2_b32 v[72:73], v9 offset0:160 offset1:161
    ds_read2_b32 v[74:75], v9 offset0:162 offset1:163
    v_mfma_f32_16x16x32_bf16 v[60:63], v[76:79], v[112:115], v[60:63]
    ds_read_b128 v[112:115], v12 offset:2176
    v_mfma_f32_16x16x32_bf16 v[56:59], v[76:79], v[108:111], v[56:59]
    v_mfma_f32_16x16x32_bf16 v[52:55], v[76:79], v[104:107], v[52:55]
    v_mfma_f32_16x16x32_bf16 v[48:51], v[76:79], v[100:103], v[48:51]
    v_mfma_f32_16x16x32_bf16 v[44:47], v[76:79], v[96:99], v[44:47]
    ds_read2_b32 v[76:77], v9 offset0:32 offset1:33
    ds_read2_b32 v[78:79], v9 offset0:34 offset1:35
    v_mfma_f32_16x16x32_bf16 v[60:63], v[80:83], v[108:111], v[60:63]
    ds_read_b128 v[108:111], v12 offset:1664
    v_mfma_f32_16x16x32_bf16 v[56:59], v[80:83], v[104:107], v[56:59]
    v_mfma_f32_16x16x32_bf16 v[52:55], v[80:83], v[100:103], v[52:55]
    v_mfma_f32_16x16x32_bf16 v[48:51], v[80:83], v[96:99], v[48:51]
    ds_read2_b32 v[80:81], v10 offset0:160 offset1:161
    ds_read2_b32 v[82:83], v10 offset0:162 offset1:163
    v_mfma_f32_16x16x32_bf16 v[60:63], v[84:87], v[104:107], v[60:63]
    ds_read_b128 v[104:107], v12 offset:1152
    v_mfma_f32_16x16x32_bf16 v[56:59], v[84:87], v[100:103], v[56:59]
    v_mfma_f32_16x16x32_bf16 v[52:55], v[84:87], v[96:99], v[52:55]
    ds_read2_b32 v[84:85], v10 offset0:32 offset1:33
    ds_read2_b32 v[86:87], v10 offset0:34 offset1:35
    v_mfma_f32_16x16x32_bf16 v[60:63], v[88:91], v[100:103], v[60:63]
    ds_read_b128 v[100:103], v12 offset:640
    v_mfma_f32_16x16x32_bf16 v[56:59], v[88:91], v[96:99], v[56:59]
    ds_read2_b32 v[88:89], v11 offset0:160 offset1:161
    ds_read2_b32 v[90:91], v11 offset0:162 offset1:163
    v_mfma_f32_16x16x32_bf16 v[60:63], v[92:95], v[96:99], v[60:63]
    ds_read_b128 v[96:99], v12 offset:128
    ds_read2_b32 v[92:93], v11 offset0:32 offset1:33
    ds_read2_b32 v[94:95], v11 offset0:34 offset1:35
    s_waitcnt lgkmcnt(14)
    v_mfma_f32_16x16x32_bf16 v[60:63], v[64:67], v[124:127], v[60:63]
    ds_read_b128 v[124:127], v12 offset:3648
    v_mfma_f32_16x16x32_bf16 v[56:59], v[64:67], v[120:123], v[56:59]
    v_mfma_f32_16x16x32_bf16 v[52:55], v[64:67], v[116:119], v[52:55]
    v_mfma_f32_16x16x32_bf16 v[48:51], v[64:67], v[112:115], v[48:51]
    s_waitcnt lgkmcnt(12)
    v_mfma_f32_16x16x32_bf16 v[44:47], v[64:67], v[108:111], v[44:47]
    s_waitcnt lgkmcnt(9)
    v_mfma_f32_16x16x32_bf16 v[40:43], v[64:67], v[104:107], v[40:43]
    s_waitcnt lgkmcnt(6)
    v_mfma_f32_16x16x32_bf16 v[36:39], v[64:67], v[100:103], v[36:39]
    s_waitcnt lgkmcnt(3)
    v_mfma_f32_16x16x32_bf16 v[32:35], v[64:67], v[96:99], v[32:35]
    ds_read2_b32 v[64:65], v8 offset0:144 offset1:145
    ds_read2_b32 v[66:67], v8 offset0:146 offset1:147
    v_mfma_f32_16x16x32_bf16 v[60:63], v[68:71], v[120:123], v[60:63]
    ds_read_b128 v[120:123], v12 offset:3136
    v_mfma_f32_16x16x32_bf16 v[56:59], v[68:71], v[116:119], v[56:59]
    v_mfma_f32_16x16x32_bf16 v[52:55], v[68:71], v[112:115], v[52:55]
    v_mfma_f32_16x16x32_bf16 v[48:51], v[68:71], v[108:111], v[48:51]
    v_mfma_f32_16x16x32_bf16 v[44:47], v[68:71], v[104:107], v[44:47]
    v_mfma_f32_16x16x32_bf16 v[40:43], v[68:71], v[100:103], v[40:43]
    v_mfma_f32_16x16x32_bf16 v[36:39], v[68:71], v[96:99], v[36:39]
    ds_read2_b32 v[68:69], v8 offset0:16 offset1:17
    ds_read2_b32 v[70:71], v8 offset0:18 offset1:19
    v_mfma_f32_16x16x32_bf16 v[60:63], v[72:75], v[116:119], v[60:63]
    ds_read_b128 v[116:119], v12 offset:2624
    v_mfma_f32_16x16x32_bf16 v[56:59], v[72:75], v[112:115], v[56:59]
    v_mfma_f32_16x16x32_bf16 v[52:55], v[72:75], v[108:111], v[52:55]
    v_mfma_f32_16x16x32_bf16 v[48:51], v[72:75], v[104:107], v[48:51]
    v_mfma_f32_16x16x32_bf16 v[44:47], v[72:75], v[100:103], v[44:47]
    v_mfma_f32_16x16x32_bf16 v[40:43], v[72:75], v[96:99], v[40:43]
    ds_read2_b32 v[72:73], v9 offset0:144 offset1:145
    ds_read2_b32 v[74:75], v9 offset0:146 offset1:147
    v_mfma_f32_16x16x32_bf16 v[60:63], v[76:79], v[112:115], v[60:63]
    ds_read_b128 v[112:115], v12 offset:2112
    v_mfma_f32_16x16x32_bf16 v[56:59], v[76:79], v[108:111], v[56:59]
    v_mfma_f32_16x16x32_bf16 v[52:55], v[76:79], v[104:107], v[52:55]
    v_mfma_f32_16x16x32_bf16 v[48:51], v[76:79], v[100:103], v[48:51]
    v_mfma_f32_16x16x32_bf16 v[44:47], v[76:79], v[96:99], v[44:47]
    ds_read2_b32 v[76:77], v9 offset0:16 offset1:17
    ds_read2_b32 v[78:79], v9 offset0:18 offset1:19
    v_mfma_f32_16x16x32_bf16 v[60:63], v[80:83], v[108:111], v[60:63]
    ds_read_b128 v[108:111], v12 offset:1600
    v_mfma_f32_16x16x32_bf16 v[56:59], v[80:83], v[104:107], v[56:59]
    v_mfma_f32_16x16x32_bf16 v[52:55], v[80:83], v[100:103], v[52:55]
    v_mfma_f32_16x16x32_bf16 v[48:51], v[80:83], v[96:99], v[48:51]
    ds_read2_b32 v[80:81], v10 offset0:144 offset1:145
    ds_read2_b32 v[82:83], v10 offset0:146 offset1:147
    v_mfma_f32_16x16x32_bf16 v[60:63], v[84:87], v[104:107], v[60:63]
    ds_read_b128 v[104:107], v12 offset:1088
    v_mfma_f32_16x16x32_bf16 v[56:59], v[84:87], v[100:103], v[56:59]
    v_mfma_f32_16x16x32_bf16 v[52:55], v[84:87], v[96:99], v[52:55]
    ds_read2_b32 v[84:85], v10 offset0:16 offset1:17
    ds_read2_b32 v[86:87], v10 offset0:18 offset1:19
    v_mfma_f32_16x16x32_bf16 v[60:63], v[88:91], v[100:103], v[60:63]
    ds_read_b128 v[100:103], v12 offset:576
    v_mfma_f32_16x16x32_bf16 v[56:59], v[88:91], v[96:99], v[56:59]
    ds_read2_b32 v[88:89], v11 offset0:144 offset1:145
    ds_read2_b32 v[90:91], v11 offset0:146 offset1:147
    s_waitcnt lgkmcnt(14)
    v_mfma_f32_16x16x32_bf16 v[60:63], v[92:95], v[96:99], v[60:63]
    ds_read_b128 v[96:99], v12 offset:64
    ds_read2_b32 v[92:93], v11 offset0:16 offset1:17
    ds_read2_b32 v[94:95], v11 offset0:18 offset1:19
    v_mfma_f32_16x16x32_bf16 v[60:63], v[64:67], v[124:127], v[60:63]
    ds_read_b128 v[124:127], v12 offset:3584
    v_mfma_f32_16x16x32_bf16 v[56:59], v[64:67], v[120:123], v[56:59]
    v_mfma_f32_16x16x32_bf16 v[52:55], v[64:67], v[116:119], v[52:55]
    s_waitcnt lgkmcnt(14)
    v_mfma_f32_16x16x32_bf16 v[48:51], v[64:67], v[112:115], v[48:51]
    s_waitcnt lgkmcnt(12)
    v_mfma_f32_16x16x32_bf16 v[44:47], v[64:67], v[108:111], v[44:47]
    s_waitcnt lgkmcnt(9)
    v_mfma_f32_16x16x32_bf16 v[40:43], v[64:67], v[104:107], v[40:43]
    s_waitcnt lgkmcnt(6)
    v_mfma_f32_16x16x32_bf16 v[36:39], v[64:67], v[100:103], v[36:39]
    s_waitcnt lgkmcnt(3)
    v_mfma_f32_16x16x32_bf16 v[32:35], v[64:67], v[96:99], v[32:35]
    ds_read2_b32 v[64:65], v8 offset0:128 offset1:129
    ds_read2_b32 v[66:67], v8 offset0:130 offset1:131
    v_mfma_f32_16x16x32_bf16 v[60:63], v[68:71], v[120:123], v[60:63]
    ds_read_b128 v[120:123], v12 offset:3072
    v_mfma_f32_16x16x32_bf16 v[56:59], v[68:71], v[116:119], v[56:59]
    v_mfma_f32_16x16x32_bf16 v[52:55], v[68:71], v[112:115], v[52:55]
    v_mfma_f32_16x16x32_bf16 v[48:51], v[68:71], v[108:111], v[48:51]
    v_mfma_f32_16x16x32_bf16 v[44:47], v[68:71], v[104:107], v[44:47]
    v_mfma_f32_16x16x32_bf16 v[40:43], v[68:71], v[100:103], v[40:43]
    v_mfma_f32_16x16x32_bf16 v[36:39], v[68:71], v[96:99], v[36:39]
    ds_read2_b32 v[68:69], v8 offset0:0 offset1:1
    ds_read2_b32 v[70:71], v8 offset0:2 offset1:3
    v_mfma_f32_16x16x32_bf16 v[60:63], v[72:75], v[116:119], v[60:63]
    ds_read_b128 v[116:119], v12 offset:2560
    v_mfma_f32_16x16x32_bf16 v[56:59], v[72:75], v[112:115], v[56:59]
    v_mfma_f32_16x16x32_bf16 v[52:55], v[72:75], v[108:111], v[52:55]
    v_mfma_f32_16x16x32_bf16 v[48:51], v[72:75], v[104:107], v[48:51]
    v_mfma_f32_16x16x32_bf16 v[44:47], v[72:75], v[100:103], v[44:47]
    v_mfma_f32_16x16x32_bf16 v[40:43], v[72:75], v[96:99], v[40:43]
    ds_read2_b32 v[72:73], v9 offset0:128 offset1:129
    ds_read2_b32 v[74:75], v9 offset0:130 offset1:131
    v_mfma_f32_16x16x32_bf16 v[60:63], v[76:79], v[112:115], v[60:63]
    ds_read_b128 v[112:115], v12 offset:2048
    v_mfma_f32_16x16x32_bf16 v[56:59], v[76:79], v[108:111], v[56:59]
    v_mfma_f32_16x16x32_bf16 v[52:55], v[76:79], v[104:107], v[52:55]
    v_mfma_f32_16x16x32_bf16 v[48:51], v[76:79], v[100:103], v[48:51]
    v_mfma_f32_16x16x32_bf16 v[44:47], v[76:79], v[96:99], v[44:47]
    ds_read2_b32 v[76:77], v9 offset0:0 offset1:1
    ds_read2_b32 v[78:79], v9 offset0:2 offset1:3
    v_mfma_f32_16x16x32_bf16 v[60:63], v[80:83], v[108:111], v[60:63]
    ds_read_b128 v[108:111], v12 offset:1536
    v_mfma_f32_16x16x32_bf16 v[56:59], v[80:83], v[104:107], v[56:59]
    v_mfma_f32_16x16x32_bf16 v[52:55], v[80:83], v[100:103], v[52:55]
    v_mfma_f32_16x16x32_bf16 v[48:51], v[80:83], v[96:99], v[48:51]
    ds_read2_b32 v[80:81], v10 offset0:128 offset1:129
    ds_read2_b32 v[82:83], v10 offset0:130 offset1:131
    v_mfma_f32_16x16x32_bf16 v[60:63], v[84:87], v[104:107], v[60:63]
    ds_read_b128 v[104:107], v12 offset:1024
    v_mfma_f32_16x16x32_bf16 v[56:59], v[84:87], v[100:103], v[56:59]
    v_mfma_f32_16x16x32_bf16 v[52:55], v[84:87], v[96:99], v[52:55]
    ds_read2_b32 v[84:85], v10 offset0:0 offset1:1
    ds_read2_b32 v[86:87], v10 offset0:2 offset1:3
    v_mfma_f32_16x16x32_bf16 v[60:63], v[88:91], v[100:103], v[60:63]
    ds_read_b128 v[100:103], v12 offset:512
    v_mfma_f32_16x16x32_bf16 v[56:59], v[88:91], v[96:99], v[56:59]
    ds_read2_b32 v[88:89], v11 offset0:128 offset1:129
    ds_read2_b32 v[90:91], v11 offset0:130 offset1:131
    s_waitcnt lgkmcnt(14)
    v_mfma_f32_16x16x32_bf16 v[60:63], v[92:95], v[96:99], v[60:63]
    ds_read_b128 v[96:99], v12 offset:0
    ds_read2_b32 v[92:93], v11 offset0:0 offset1:1
    ds_read2_b32 v[94:95], v11 offset0:2 offset1:3
    ds_write_b32 v14, v26 offset:48
    v_mfma_f32_16x16x32_bf16 v[60:63], v[64:67], v[124:127], v[60:63]
    v_mfma_f32_16x16x32_bf16 v[56:59], v[64:67], v[120:123], v[56:59]
    v_mfma_f32_16x16x32_bf16 v[52:55], v[64:67], v[116:119], v[52:55]
    s_waitcnt lgkmcnt(14)
    v_mfma_f32_16x16x32_bf16 v[48:51], v[64:67], v[112:115], v[48:51]
    s_waitcnt lgkmcnt(12)
    v_mfma_f32_16x16x32_bf16 v[44:47], v[64:67], v[108:111], v[44:47]
    s_waitcnt lgkmcnt(9)
    v_mfma_f32_16x16x32_bf16 v[40:43], v[64:67], v[104:107], v[40:43]
    s_waitcnt lgkmcnt(6)
    v_mfma_f32_16x16x32_bf16 v[36:39], v[64:67], v[100:103], v[36:39]
    s_waitcnt lgkmcnt(3)
    v_mfma_f32_16x16x32_bf16 v[32:35], v[64:67], v[96:99], v[32:35]
    v_mfma_f32_16x16x32_bf16 v[60:63], v[68:71], v[120:123], v[60:63]
    v_mfma_f32_16x16x32_bf16 v[56:59], v[68:71], v[116:119], v[56:59]
    v_mfma_f32_16x16x32_bf16 v[52:55], v[68:71], v[112:115], v[52:55]
    v_mfma_f32_16x16x32_bf16 v[48:51], v[68:71], v[108:111], v[48:51]
    v_mfma_f32_16x16x32_bf16 v[44:47], v[68:71], v[104:107], v[44:47]
    v_mfma_f32_16x16x32_bf16 v[40:43], v[68:71], v[100:103], v[40:43]
    v_mfma_f32_16x16x32_bf16 v[36:39], v[68:71], v[96:99], v[36:39]
    v_mfma_f32_16x16x32_bf16 v[60:63], v[72:75], v[116:119], v[60:63]
    v_mfma_f32_16x16x32_bf16 v[56:59], v[72:75], v[112:115], v[56:59]
    v_mfma_f32_16x16x32_bf16 v[52:55], v[72:75], v[108:111], v[52:55]
    v_mfma_f32_16x16x32_bf16 v[48:51], v[72:75], v[104:107], v[48:51]
    v_mfma_f32_16x16x32_bf16 v[44:47], v[72:75], v[100:103], v[44:47]
    v_mfma_f32_16x16x32_bf16 v[40:43], v[72:75], v[96:99], v[40:43]
    v_mfma_f32_16x16x32_bf16 v[60:63], v[76:79], v[112:115], v[60:63]
    v_mfma_f32_16x16x32_bf16 v[56:59], v[76:79], v[108:111], v[56:59]
    v_mfma_f32_16x16x32_bf16 v[52:55], v[76:79], v[104:107], v[52:55]
    v_mfma_f32_16x16x32_bf16 v[48:51], v[76:79], v[100:103], v[48:51]
    v_mfma_f32_16x16x32_bf16 v[44:47], v[76:79], v[96:99], v[44:47]
    ds_read_b32 v20, v15 offset:48
    v_mfma_f32_16x16x32_bf16 v[60:63], v[80:83], v[108:111], v[60:63]
    v_mfma_f32_16x16x32_bf16 v[56:59], v[80:83], v[104:107], v[56:59]
    v_mfma_f32_16x16x32_bf16 v[52:55], v[80:83], v[100:103], v[52:55]
    v_mfma_f32_16x16x32_bf16 v[48:51], v[80:83], v[96:99], v[48:51]
    v_mfma_f32_16x16x32_bf16 v[60:63], v[84:87], v[104:107], v[60:63]
    v_mfma_f32_16x16x32_bf16 v[56:59], v[84:87], v[100:103], v[56:59]
    v_mfma_f32_16x16x32_bf16 v[52:55], v[84:87], v[96:99], v[52:55]
    v_mfma_f32_16x16x32_bf16 v[60:63], v[88:91], v[100:103], v[60:63]
    v_mfma_f32_16x16x32_bf16 v[56:59], v[88:91], v[96:99], v[56:59]
    s_waitcnt lgkmcnt(2)
    v_mfma_f32_16x16x32_bf16 v[60:63], v[92:95], v[96:99], v[60:63]
    s_waitcnt lgkmcnt(0)
    v_readfirstlane_b32 s4, v20
    s_nop 0
    s_cmp_ge_u32 s4, 1
    s_cbranch_scc1 Lc57
    s_mov_b32 s5, 0x8000
Lp58:
    ds_read_b32 v20, v15 offset:48
    s_waitcnt lgkmcnt(0)
    v_readfirstlane_b32 s4, v20
    s_nop 0
    s_cmp_ge_u32 s4, 1
    s_cbranch_scc1 Lpe59
    s_sub_u32 s5, s5, 1
    s_cmp_lg_u32 s5, 0
    s_cbranch_scc1 Lp58
Lpe59:
Lc57:
    s_cmp_eq_u32 s15, 0
    s_cbranch_scc1 Lc60
    s_nop 3
    ds_write_b128 v17, v[32:35] offset:0
    ds_write_b128 v17, v[36:39] offset:1024
    ds_write_b128 v17, v[40:43] offset:2048
    ds_write_b128 v17, v[44:47] offset:3072
    ds_write_b32 v14, v26 offset:64
    s_mov_b32 s5, 0x8000
Lp62:
    ds_read_b32 v20, v15 offset:64
    s_waitcnt lgkmcnt(0)
    v_readfirstlane_b32 s4, v20
    s_nop 0
    s_cmp_ge_u32 s4, 1
    s_cbranch_scc1 Lpe63
    s_sub_u32 s5, s5, 1
    s_cmp_lg_u32 s5, 0
    s_cbranch_scc1 Lp62
Lpe63:
    ds_read_b128 v[64:67], v18 offset:0
    ds_read_b128 v[68:71], v18 offset:1024
    ds_read_b128 v[72:75], v18 offset:2048
    ds_read_b128 v[76:79], v18 offset:3072
    s_waitcnt lgkmcnt(3)
    v_add_f32 v48, v48, v64
    v_add_f32 v49, v49, v65
    v_add_f32 v50, v50, v66
    v_add_f32 v51, v51, v67
    v_cvt_pk_bf16_f32 v80, v48, v49
    v_cvt_pk_bf16_f32 v81, v50, v51
    ds_write_b64 v19, v[80:81] offset:0
    s_waitcnt lgkmcnt(3)
    v_add_f32 v52, v52, v68
    v_add_f32 v53, v53, v69
    v_add_f32 v54, v54, v70
    v_add_f32 v55, v55, v71
    v_cvt_pk_bf16_f32 v82, v52, v53
    v_cvt_pk_bf16_f32 v83, v54, v55
    ds_write_b64 v19, v[82:83] offset:512
    s_waitcnt lgkmcnt(3)
    v_add_f32 v56, v56, v72
    v_add_f32 v57, v57, v73
    v_add_f32 v58, v58, v74
    v_add_f32 v59, v59, v75
    v_cvt_pk_bf16_f32 v84, v56, v57
    v_cvt_pk_bf16_f32 v85, v58, v59
    ds_write_b64 v19, v[84:85] offset:1024
    s_waitcnt lgkmcnt(3)
    v_add_f32 v60, v60, v76
    v_add_f32 v61, v61, v77
    v_add_f32 v62, v62, v78
    v_add_f32 v63, v63, v79
    v_cvt_pk_bf16_f32 v86, v60, v61
    v_cvt_pk_bf16_f32 v87, v62, v63
    ds_write_b64 v19, v[86:87] offset:1536
    s_branch Lc61
Lc60:
    s_nop 3
    ds_write_b128 v17, v[48:51] offset:0
    ds_write_b128 v17, v[52:55] offset:1024
    ds_write_b128 v17, v[56:59] offset:2048
    ds_write_b128 v17, v[60:63] offset:3072
    ds_write_b32 v14, v26 offset:64
    s_mov_b32 s5, 0x8000
Lp64:
    ds_read_b32 v20, v15 offset:64
    s_waitcnt lgkmcnt(0)
    v_readfirstlane_b32 s4, v20
    s_nop 0
    s_cmp_ge_u32 s4, 1
    s_cbranch_scc1 Lpe65
    s_sub_u32 s5, s5, 1
    s_cmp_lg_u32 s5, 0
    s_cbranch_scc1 Lp64
Lpe65:
    ds_read_b128 v[64:67], v18 offset:0
    ds_read_b128 v[68:71], v18 offset:1024
    ds_read_b128 v[72:75], v18 offset:2048
    ds_read_b128 v[76:79], v18 offset:3072
    s_waitcnt lgkmcnt(3)
    v_add_f32 v32, v32, v64
    v_add_f32 v33, v33, v65
    v_add_f32 v34, v34, v66
    v_add_f32 v35, v35, v67
    v_cvt_pk_bf16_f32 v80, v32, v33
    v_cvt_pk_bf16_f32 v81, v34, v35
    ds_write_b64 v19, v[80:81] offset:0
    s_waitcnt lgkmcnt(3)
    v_add_f32 v36, v36, v68
    v_add_f32 v37, v37, v69
    v_add_f32 v38, v38, v70
    v_add_f32 v39, v39, v71
    v_cvt_pk_bf16_f32 v82, v36, v37
    v_cvt_pk_bf16_f32 v83, v38, v39
    ds_write_b64 v19, v[82:83] offset:512
    s_waitcnt lgkmcnt(3)
    v_add_f32 v40, v40, v72
    v_add_f32 v41, v41, v73
    v_add_f32 v42, v42, v74
    v_add_f32 v43, v43, v75
    v_cvt_pk_bf16_f32 v84, v40, v41
    v_cvt_pk_bf16_f32 v85, v42, v43
    ds_write_b64 v19, v[84:85] offset:1024
    s_waitcnt lgkmcnt(3)
    v_add_f32 v44, v44, v76
    v_add_f32 v45, v45, v77
    v_add_f32 v46, v46, v78
    v_add_f32 v47, v47, v79
    v_cvt_pk_bf16_f32 v86, v44, v45
    v_cvt_pk_bf16_f32 v87, v46, v47
    ds_write_b64 v19, v[86:87] offset:1536
Lc61:
    ds_read_b128 v[88:91], v18
    ds_read_b128 v[92:95], v18 offset:1024
    s_mov_b64 exec, 1
    ds_add_u32 v2, v26 offset:80
    s_mov_b64 exec, -1
    s_waitcnt lgkmcnt(2)
    buffer_store_dwordx4 v[88:91], v6, s[64:67], s6 offen sc1
    s_waitcnt lgkmcnt(1)
    buffer_store_dwordx4 v[92:95], v6, s[64:67], s6 offen offset:1024 sc1
    s_mov_b64 exec, 1
    s_waitcnt vmcnt(0)
    buffer_store_dword v24, v25, s[64:67], s7 offen sc1
    s_endpgm
L_G:
    s_setprio 3
    s_sub_u32 s13, s3, 6
    s_and_b32 s14, s13, 1
    s_lshr_b32 s15, s13, 1
    v_and_b32 v13, 31, v1
    v_bfe_u32 v14, v1, 1, 3
    v_lshrrev_b32 v15, 5, v1
    v_xor_b32 v14, v14, v15
    v_lshlrev_b32 v14, 4, v14
    v_lshl_add_u32 v13, v13, 7, v14
    s_lshl_b32 s7, s14, 13
    v_add_u32 v6, s7, v13
    v_xor_b32 v7, 32, v6
    v_xor_b32 v8, 64, v6
    v_xor_b32 v9, 96, v6
    v_bfe_u32 v13, v1, 4, 1
    v_bfe_u32 v14, v1, 2, 2
    v_lshl_add_u32 v15, v15, 3, v14
    v_lshlrev_b32 v15, 6, v15
    v_and_b32 v14, 3, v1
    v_lshl_add_u32 v15, v14, 3, v15
    v_mul_u32_u24 v14, 12320, v13
    v_add_u32 v15, v15, v14
    s_mul_i32 s8, s15, 3
    s_add_u32 s8, s8, 0
    s_and_b32 s9, s8, 1
    s_lshl_b32 s9, s9, 5
    s_lshr_b32 s8, s8, 1
    s_lshl_b32 s8, s8, 10
    s_add_u32 s8, s8, 16384
    v_xor_b32 v3, s9, v15
    v_add_u32 v3, s8, v3
    s_mul_i32 s8, s15, 3
    s_add_u32 s8, s8, 1
    s_and_b32 s9, s8, 1
    s_lshl_b32 s9, s9, 5
    s_lshr_b32 s8, s8, 1
    s_lshl_b32 s8, s8, 10
    s_add_u32 s8, s8, 16384
    v_xor_b32 v4, s9, v15
    v_add_u32 v4, s8, v4
    s_mul_i32 s8, s15, 3
    s_add_u32 s8, s8, 2
    s_and_b32 s9, s8, 1
    s_lshl_b32 s9, s9, 5
    s_lshr_b32 s8, s8, 1
    s_lshl_b32 s8, s8, 10
    s_add_u32 s8, s8, 16384
    v_xor_b32 v5, s9, v15
    v_add_u32 v5, s8, v5
    s_lshl_b32 s8, s13, 2
    v_add_u32 v10, s8, v2
    v_lshlrev_b32 v12, 4, v1
    s_lshl_b32 s8, s71, 1
    s_add_u32 s8, s8, s14
    s_mul_i32 s76, s8, 180224
    s_add_u32 s76, s76, 8388608
    s_lshl_b32 s8, s8, 5
    s_lshl_b32 s9, s72, 1
    s_add_u32 s9, s9, s15
    s_add_u32 s8, s8, s9
    s_lshl_b32 s8, s8, 7
    s_add_u32 s78, s8, 393216
    s_mul_i32 s9, s9, 3072
    s_add_u32 s76, s76, s9
    s_add_u32 s77, s76, 90112
    v_and_b32 v14, 1, v1
    v_cmp_eq_u32 vcc, v13, v14
    v_mov_b32 v14, 0x3f803f80
    s_nop 0
    v_cndmask_b32 v13, 0, v14, vcc
    s_bfe_u32 s11, s71, 0x10002
    s_cmp_eq_u32 s11, 0
    s_cselect_b32 s10, -1, 0
    s_cselect_b32 s11, 0, -1
    v_and_b32 v16, s10, v13
    v_and_b32 v17, s10, v13
    v_and_b32 v18, s10, v13
    v_and_b32 v19, s10, v13
    s_waitcnt lgkmcnt(0)
    s_barrier
    s_add_u32 s68, s68, 1
    s_add_u32 s8, s74, s15
    s_cmp_ge_u32 s8, 2
    s_cselect_b32 s8, s74, 0
    s_cmp_lg_u32 s8, 0
    s_cbranch_scc1 L_Gskip
    s_mov_b32 s5, 0x8000
Lp66:
    ds_read_b32 v11, v2 offset:0
    s_waitcnt lgkmcnt(0)
    v_readfirstlane_b32 s4, v11
    s_nop 0
    s_cmp_ge_u32 s4, 2
    s_cbranch_scc1 Lpe67
    s_sleep 1
    s_sub_u32 s5, s5, 1
    s_cmp_lg_u32 s5, 0
    s_cbranch_scc1 Lp66
Lpe67:
    ds_read_b128 v[44:47], v6 offset:0
    ds_read_b64_tr_b16 v[32:33], v3 offset:0
    ds_read_b64_tr_b16 v[34:35], v3 offset:256
    ds_read_b64_tr_b16 v[36:37], v4 offset:0
    ds_read_b64_tr_b16 v[38:39], v4 offset:256
    ds_read_b64_tr_b16 v[40:41], v5 offset:0
    ds_read_b64_tr_b16 v[42:43], v5 offset:256
    ds_read_b128 v[48:51], v6 offset:4096
    v_add_u32 v6, 45056, v6
    ds_read_b128 v[64:67], v7 offset:0
    ds_read_b64_tr_b16 v[52:53], v3 offset:3072
    ds_read_b64_tr_b16 v[54:55], v3 offset:3328
    ds_read_b64_tr_b16 v[56:57], v4 offset:3072
    ds_read_b64_tr_b16 v[58:59], v4 offset:3328
    ds_read_b64_tr_b16 v[60:61], v5 offset:3072
    ds_read_b64_tr_b16 v[62:63], v5 offset:3328
    ds_read_b128 v[68:71], v7 offset:4096
    v_add_u32 v7, 45056, v7
    ds_read_b32 v11, v2 offset:0
    s_waitcnt lgkmcnt(14)
    v_mfma_f32_32x32x16_bf16 v[72:87], v[32:35], v[44:47], 0
    s_waitcnt lgkmcnt(0)
    v_readfirstlane_b32 s4, v11
    v_mfma_f32_32x32x16_bf16 v[88:103], v[36:39], v[44:47], 0
    s_cmp_lt_u32 s4, 4
    s_cbranch_scc1 Lgs68
Lgr69:
    v_mfma_f32_32x32x16_bf16 v[104:119], v[40:43], v[44:47], 0
    ds_read_b128 v[44:47], v8 offset:0
    v_mfma_f32_32x32x16_bf16 v[120:135], v[32:35], v[48:51], 0
    v_mfma_f32_16x16x32_bf16 v[20:23], v[16:19], v[32:35], 0
    ds_read_b64_tr_b16 v[32:33], v3 offset:6144
    ds_read_b64_tr_b16 v[34:35], v3 offset:6400
    v_mfma_f32_32x32x16_bf16 v[136:151], v[36:39], v[48:51], 0
    v_mfma_f32_16x16x32_bf16 v[24:27], v[16:19], v[36:39], 0
    ds_read_b64_tr_b16 v[36:37], v4 offset:6144
    ds_read_b64_tr_b16 v[38:39], v4 offset:6400
    v_mfma_f32_32x32x16_bf16 v[152:167], v[40:43], v[48:51], 0
    v_mfma_f32_16x16x32_bf16 v[28:31], v[16:19], v[40:43], 0
    ds_read_b64_tr_b16 v[40:41], v5 offset:6144
    ds_read_b64_tr_b16 v[42:43], v5 offset:6400
    ds_read_b128 v[48:51], v8 offset:4096
    v_mfma_f32_32x32x16_bf16 v[72:87], v[52:55], v[64:67], v[72:87]
    ds_read_b32 v11, v2 offset:0
    v_add_u32 v8, 45056, v8
    v_mfma_f32_32x32x16_bf16 v[88:103], v[56:59], v[64:67], v[88:103]
    v_mfma_f32_32x32x16_bf16 v[104:119], v[60:63], v[64:67], v[104:119]
    ds_read_b128 v[64:67], v9 offset:0
    v_mfma_f32_32x32x16_bf16 v[120:135], v[52:55], v[68:71], v[120:135]
    v_mfma_f32_16x16x32_bf16 v[20:23], v[16:19], v[52:55], v[20:23]
    ds_read_b64_tr_b16 v[52:53], v3 offset:9216
    ds_read_b64_tr_b16 v[54:55], v3 offset:9472
    v_mfma_f32_32x32x16_bf16 v[136:151], v[56:59], v[68:71], v[136:151]
    v_mfma_f32_16x16x32_bf16 v[24:27], v[16:19], v[56:59], v[24:27]
    ds_read_b64_tr_b16 v[56:57], v4 offset:9216
    ds_read_b64_tr_b16 v[58:59], v4 offset:9472
    v_mfma_f32_32x32x16_bf16 v[152:167], v[60:63], v[68:71], v[152:167]
    v_mfma_f32_16x16x32_bf16 v[28:31], v[16:19], v[60:63], v[28:31]
    ds_read_b64_tr_b16 v[60:61], v5 offset:9216
    ds_read_b64_tr_b16 v[62:63], v5 offset:9472
    ds_read_b128 v[68:71], v9 offset:4096
    s_waitcnt lgkmcnt(14)
    v_mfma_f32_32x32x16_bf16 v[72:87], v[32:35], v[44:47], v[72:87]
    s_waitcnt lgkmcnt(8)
    v_readfirstlane_b32 s4, v11
    v_add_u32 v9, 45056, v9
    v_mov_b32 v14, 1
    ds_write_b32 v10, v14 offset:16
    v_mfma_f32_32x32x16_bf16 v[88:103], v[36:39], v[44:47], v[88:103]
    s_cmp_lt_u32 s4, 6
    s_cbranch_scc1 Lgs72
Lgr73:
    v_add_u32 v3, 45056, v3
    v_add_u32 v4, 45056, v4
    v_add_u32 v5, 45056, v5
    v_mfma_f32_32x32x16_bf16 v[104:119], v[40:43], v[44:47], v[104:119]
    ds_read_b128 v[44:47], v6 offset:0
    v_mfma_f32_32x32x16_bf16 v[120:135], v[32:35], v[48:51], v[120:135]
    v_mfma_f32_16x16x32_bf16 v[20:23], v[16:19], v[32:35], v[20:23]
    ds_read_b64_tr_b16 v[32:33], v3 offset:0
    ds_read_b64_tr_b16 v[34:35], v3 offset:256
    v_mfma_f32_32x32x16_bf16 v[136:151], v[36:39], v[48:51], v[136:151]
    v_mfma_f32_16x16x32_bf16 v[24:27], v[16:19], v[36:39], v[24:27]
    ds_read_b64_tr_b16 v[36:37], v4 offset:0
    ds_read_b64_tr_b16 v[38:39], v4 offset:256
    v_mfma_f32_32x32x16_bf16 v[152:167], v[40:43], v[48:51], v[152:167]
    v_mfma_f32_16x16x32_bf16 v[28:31], v[16:19], v[40:43], v[28:31]
    ds_read_b64_tr_b16 v[40:41], v5 offset:0
    ds_read_b64_tr_b16 v[42:43], v5 offset:256
    ds_read_b128 v[48:51], v6 offset:4096
    s_waitcnt lgkmcnt(14)
    v_mfma_f32_32x32x16_bf16 v[72:87], v[52:55], v[64:67], v[72:87]
    ds_read_b32 v11, v2 offset:0
    v_add_u32 v6, 45056, v6
    s_waitcnt lgkmcnt(13)
    v_mfma_f32_32x32x16_bf16 v[88:103], v[56:59], v[64:67], v[88:103]
    s_waitcnt lgkmcnt(11)
    v_mfma_f32_32x32x16_bf16 v[104:119], v[60:63], v[64:67], v[104:119]
    ds_read_b128 v[64:67], v7 offset:0
    s_waitcnt lgkmcnt(11)
    v_mfma_f32_32x32x16_bf16 v[120:135], v[52:55], v[68:71], v[120:135]
    v_mfma_f32_16x16x32_bf16 v[20:23], v[16:19], v[52:55], v[20:23]
    ds_read_b64_tr_b16 v[52:53], v3 offset:3072
    ds_read_b64_tr_b16 v[54:55], v3 offset:3328
    v_mfma_f32_32x32x16_bf16 v[136:151], v[56:59], v[68:71], v[136:151]
    v_mfma_f32_16x16x32_bf16 v[24:27], v[16:19], v[56:59], v[24:27]
    ds_read_b64_tr_b16 v[56:57], v4 offset:3072
    ds_read_b64_tr_b16 v[58:59], v4 offset:3328
    v_mfma_f32_32x32x16_bf16 v[152:167], v[60:63], v[68:71], v[152:167]
    v_mfma_f32_16x16x32_bf16 v[28:31], v[16:19], v[60:63], v[28:31]
    ds_read_b64_tr_b16 v[60:61], v5 offset:3072
    ds_read_b64_tr_b16 v[62:63], v5 offset:3328
    ds_read_b128 v[68:71], v7 offset:4096
    v_and_b32 v16, s11, v13
    v_and_b32 v17, s11, v13
    v_and_b32 v18, s11, v13
    v_and_b32 v19, s11, v13
    s_waitcnt lgkmcnt(14)
    v_mfma_f32_32x32x16_bf16 v[72:87], v[32:35], v[44:47], v[72:87]
    s_waitcnt lgkmcnt(8)
    v_readfirstlane_b32 s4, v11
    v_add_u32 v7, 45056, v7
    v_mfma_f32_32x32x16_bf16 v[88:103], v[36:39], v[44:47], v[88:103]
    s_cmp_lt_u32 s4, 8
    s_cbranch_scc1 Lgs76
Lgr77:
    v_mfma_f32_32x32x16_bf16 v[104:119], v[40:43], v[44:47], v[104:119]
    ds_read_b128 v[44:47], v8 offset:0
    v_mfma_f32_32x32x16_bf16 v[120:135], v[32:35], v[48:51], v[120:135]
    v_mfma_f32_16x16x32_bf16 v[20:23], v[16:19], v[32:35], v[20:23]
    ds_read_b64_tr_b16 v[32:33], v3 offset:6144
    ds_read_b64_tr_b16 v[34:35], v3 offset:6400
    v_mfma_f32_32x32x16_bf16 v[136:151], v[36:39], v[48:51], v[136:151]
    v_mfma_f32_16x16x32_bf16 v[24:27], v[16:19], v[36:39], v[24:27]
    ds_read_b64_tr_b16 v[36:37], v4 offset:6144
    ds_read_b64_tr_b16 v[38:39], v4 offset:6400
    v_mfma_f32_32x32x16_bf16 v[152:167], v[40:43], v[48:51], v[152:167]
    v_mfma_f32_16x16x32_bf16 v[28:31], v[16:19], v[40:43], v[28:31]
    ds_read_b64_tr_b16 v[40:41], v5 offset:6144
    ds_read_b64_tr_b16 v[42:43], v5 offset:6400
    ds_read_b128 v[48:51], v8 offset:4096
    s_waitcnt lgkmcnt(13)
    v_mfma_f32_32x32x16_bf16 v[72:87], v[52:55], v[64:67], v[72:87]
    ds_read_b32 v11, v2 offset:0
    v_add_u32 v8, 45056, v8
    s_waitcnt lgkmcnt(12)
    v_mfma_f32_32x32x16_bf16 v[88:103], v[56:59], v[64:67], v[88:103]
    s_waitcnt lgkmcnt(10)
    v_mfma_f32_32x32x16_bf16 v[104:119], v[60:63], v[64:67], v[104:119]
    ds_read_b128 v[64:67], v9 offset:0
    s_waitcnt lgkmcnt(10)
    v_mfma_f32_32x32x16_bf16 v[120:135], v[52:55], v[68:71], v[120:135]
    v_mfma_f32_16x16x32_bf16 v[20:23], v[16:19], v[52:55], v[20:23]
    ds_read_b64_tr_b16 v[52:53], v3 offset:9216
    ds_read_b64_tr_b16 v[54:55], v3 offset:9472
    v_mfma_f32_32x32x16_bf16 v[136:151], v[56:59], v[68:71], v[136:151]
    v_mfma_f32_16x16x32_bf16 v[24:27], v[16:19], v[56:59], v[24:27]
    ds_read_b64_tr_b16 v[56:57], v4 offset:9216
    ds_read_b64_tr_b16 v[58:59], v4 offset:9472
    v_mfma_f32_32x32x16_bf16 v[152:167], v[60:63], v[68:71], v[152:167]
    v_mfma_f32_16x16x32_bf16 v[28:31], v[16:19], v[60:63], v[28:31]
    ds_read_b64_tr_b16 v[60:61], v5 offset:9216
    ds_read_b64_tr_b16 v[62:63], v5 offset:9472
    ds_read_b128 v[68:71], v9 offset:4096
    s_waitcnt lgkmcnt(14)
    v_mfma_f32_32x32x16_bf16 v[72:87], v[32:35], v[44:47], v[72:87]
    s_waitcnt lgkmcnt(8)
    v_readfirstlane_b32 s4, v11
    v_add_u32 v9, 45056, v9
    v_mov_b32 v14, 2
    ds_write_b32 v10, v14 offset:16
    v_mfma_f32_32x32x16_bf16 v[88:103], v[36:39], v[44:47], v[88:103]
    s_cmp_lt_u32 s4, 10
    s_cbranch_scc1 Lgs80
Lgr81:
    v_add_u32 v3, 45056, v3
    v_add_u32 v4, 45056, v4
    v_add_u32 v5, 45056, v5
    v_mfma_f32_32x32x16_bf16 v[104:119], v[40:43], v[44:47], v[104:119]
    ds_read_b128 v[44:47], v6 offset:0
    v_mfma_f32_32x32x16_bf16 v[120:135], v[32:35], v[48:51], v[120:135]
    v_mfma_f32_16x16x32_bf16 v[20:23], v[16:19], v[32:35], v[20:23]
    ds_read_b64_tr_b16 v[32:33], v3 offset:0
    ds_read_b64_tr_b16 v[34:35], v3 offset:256
    v_mfma_f32_32x32x16_bf16 v[136:151], v[36:39], v[48:51], v[136:151]
    v_mfma_f32_16x16x32_bf16 v[24:27], v[16:19], v[36:39], v[24:27]
    ds_read_b64_tr_b16 v[36:37], v4 offset:0
    ds_read_b64_tr_b16 v[38:39], v4 offset:256
    v_mfma_f32_32x32x16_bf16 v[152:167], v[40:43], v[48:51], v[152:167]
    v_mfma_f32_16x16x32_bf16 v[28:31], v[16:19], v[40:43], v[28:31]
    ds_read_b64_tr_b16 v[40:41], v5 offset:0
    ds_read_b64_tr_b16 v[42:43], v5 offset:256
    ds_read_b128 v[48:51], v6 offset:4096
    s_waitcnt lgkmcnt(14)
    v_mfma_f32_32x32x16_bf16 v[72:87], v[52:55], v[64:67], v[72:87]
    ds_read_b32 v11, v2 offset:0
    v_subrev_u32 v6, 90112, v6
    s_waitcnt lgkmcnt(13)
    v_mfma_f32_32x32x16_bf16 v[88:103], v[56:59], v[64:67], v[88:103]
    s_waitcnt lgkmcnt(11)
    v_mfma_f32_32x32x16_bf16 v[104:119], v[60:63], v[64:67], v[104:119]
    ds_read_b128 v[64:67], v7 offset:0
    s_waitcnt lgkmcnt(11)
    v_mfma_f32_32x32x16_bf16 v[120:135], v[52:55], v[68:71], v[120:135]
    v_mfma_f32_16x16x32_bf16 v[20:23], v[16:19], v[52:55], v[20:23]
    ds_read_b64_tr_b16 v[52:53], v3 offset:3072
    ds_read_b64_tr_b16 v[54:55], v3 offset:3328
    v_mfma_f32_32x32x16_bf16 v[136:151], v[56:59], v[68:71], v[136:151]
    v_mfma_f32_16x16x32_bf16 v[24:27], v[16:19], v[56:59], v[24:27]
    ds_read_b64_tr_b16 v[56:57], v4 offset:3072
    ds_read_b64_tr_b16 v[58:59], v4 offset:3328
    v_mfma_f32_32x32x16_bf16 v[152:167], v[60:63], v[68:71], v[152:167]
    v_mfma_f32_16x16x32_bf16 v[28:31], v[16:19], v[60:63], v[28:31]
    ds_read_b64_tr_b16 v[60:61], v5 offset:3072
    ds_read_b64_tr_b16 v[62:63], v5 offset:3328
    ds_read_b128 v[68:71], v7 offset:4096
    s_waitcnt lgkmcnt(14)
    v_mfma_f32_32x32x16_bf16 v[72:87], v[32:35], v[44:47], v[72:87]
    s_waitcnt lgkmcnt(8)
    v_readfirstlane_b32 s4, v11
    v_subrev_u32 v7, 90112, v7
    v_mfma_f32_32x32x16_bf16 v[88:103], v[36:39], v[44:47], v[88:103]
    s_cmp_lt_u32 s4, 12
    s_cbranch_scc1 Lgs84
Lgr85:
    v_mfma_f32_32x32x16_bf16 v[104:119], v[40:43], v[44:47], v[104:119]
    ds_read_b128 v[44:47], v8 offset:0
    v_mfma_f32_32x32x16_bf16 v[120:135], v[32:35], v[48:51], v[120:135]
    ds_read_b64_tr_b16 v[32:33], v3 offset:6144
    ds_read_b64_tr_b16 v[34:35], v3 offset:6400
    v_mfma_f32_32x32x16_bf16 v[136:151], v[36:39], v[48:51], v[136:151]
    ds_read_b64_tr_b16 v[36:37], v4 offset:6144
    ds_read_b64_tr_b16 v[38:39], v4 offset:6400
    v_mfma_f32_32x32x16_bf16 v[152:167], v[40:43], v[48:51], v[152:167]
    ds_read_b64_tr_b16 v[40:41], v5 offset:6144
    ds_read_b64_tr_b16 v[42:43], v5 offset:6400
    ds_read_b128 v[48:51], v8 offset:4096
    s_cmp_eq_u32 s14, 1
    s_cbranch_scc1 Lg88
    s_mul_i32 s8, s15, 384
    s_add_u32 s8, s8, 161280
    v_lshl_add_u32 v15, v1, 2, s8
    v_mov_b32 v14, 1
    s_mov_b64 exec, 0xffff
    ds_write2_b32 v15, v20, v21 offset0:0 offset1:16
    ds_write2_b32 v15, v24, v25 offset0:32 offset1:48
    ds_write2_b32 v15, v28, v29 offset0:64 offset1:80
    s_mov_b64 exec, 1
    ds_add_u32 v2, v14 offset:84
    s_mov_b64 exec, -1
Lg88:
    s_waitcnt lgkmcnt(13)
    v_mfma_f32_32x32x16_bf16 v[72:87], v[52:55], v[64:67], v[72:87]
    ds_read_b32 v11, v2 offset:0
    v_subrev_u32 v8, 90112, v8
    s_waitcnt lgkmcnt(12)
    v_mfma_f32_32x32x16_bf16 v[88:103], v[56:59], v[64:67], v[88:103]
    s_waitcnt lgkmcnt(10)
    v_mfma_f32_32x32x16_bf16 v[104:119], v[60:63], v[64:67], v[104:119]
    ds_read_b128 v[64:67], v9 offset:0
    s_waitcnt lgkmcnt(10)
    v_mfma_f32_32x32x16_bf16 v[120:135], v[52:55], v[68:71], v[120:135]
    ds_read_b64_tr_b16 v[52:53], v3 offset:9216
    ds_read_b64_tr_b16 v[54:55], v3 offset:9472
    v_mfma_f32_32x32x16_bf16 v[136:151], v[56:59], v[68:71], v[136:151]
    ds_read_b64_tr_b16 v[56:57], v4 offset:9216
    ds_read_b64_tr_b16 v[58:59], v4 offset:9472
    v_mfma_f32_32x32x16_bf16 v[152:167], v[60:63], v[68:71], v[152:167]
    ds_read_b64_tr_b16 v[60:61], v5 offset:9216
    ds_read_b64_tr_b16 v[62:63], v5 offset:9472
    ds_read_b128 v[68:71], v9 offset:4096
    s_waitcnt lgkmcnt(14)
    v_mfma_f32_32x32x16_bf16 v[72:87], v[32:35], v[44:47], v[72:87]
    s_waitcnt lgkmcnt(8)
    v_readfirstlane_b32 s4, v11
    v_subrev_u32 v9, 90112, v9
    v_mov_b32 v14, 3
    ds_write_b32 v10, v14 offset:16
    v_mfma_f32_32x32x16_bf16 v[88:103], v[36:39], v[44:47], v[88:103]
    s_cmp_lt_u32 s4, 14
    s_cbranch_scc1 Lgs89
Lgr90:
    v_subrev_u32 v3, 90112, v3
    v_subrev_u32 v4, 90112, v4
    v_subrev_u32 v5, 90112, v5
    v_mfma_f32_32x32x16_bf16 v[104:119], v[40:43], v[44:47], v[104:119]
    ds_read_b128 v[44:47], v6 offset:0
    v_mfma_f32_32x32x16_bf16 v[120:135], v[32:35], v[48:51], v[120:135]
    ds_read_b64_tr_b16 v[32:33], v3 offset:0
    ds_read_b64_tr_b16 v[34:35], v3 offset:256
    v_mfma_f32_32x32x16_bf16 v[136:151], v[36:39], v[48:51], v[136:151]
    ds_read_b64_tr_b16 v[36:37], v4 offset:0
    ds_read_b64_tr_b16 v[38:39], v4 offset:256
    v_mfma_f32_32x32x16_bf16 v[152:167], v[40:43], v[48:51], v[152:167]
    ds_read_b64_tr_b16 v[40:41], v5 offset:0
    ds_read_b64_tr_b16 v[42:43], v5 offset:256
    ds_read_b128 v[48:51], v6 offset:4096
    s_waitcnt lgkmcnt(14)
    v_mfma_f32_32x32x16_bf16 v[72:87], v[52:55], v[64:67], v[72:87]
    ds_read_b32 v11, v2 offset:0
    v_add_u32 v6, 45056, v6
    s_waitcnt lgkmcnt(13)
    v_mfma_f32_32x32x16_bf16 v[88:103], v[56:59], v[64:67], v[88:103]
    s_waitcnt lgkmcnt(11)
    v_mfma_f32_32x32x16_bf16 v[104:119], v[60:63], v[64:67], v[104:119]
    ds_read_b128 v[64:67], v7 offset:0
    s_waitcnt lgkmcnt(11)
    v_mfma_f32_32x32x16_bf16 v[120:135], v[52:55], v[68:71], v[120:135]
    ds_read_b64_tr_b16 v[52:53], v3 offset:3072
    ds_read_b64_tr_b16 v[54:55], v3 offset:3328
    v_mfma_f32_32x32x16_bf16 v[136:151], v[56:59], v[68:71], v[136:151]
    ds_read_b64_tr_b16 v[56:57], v4 offset:3072
    ds_read_b64_tr_b16 v[58:59], v4 offset:3328
    v_mfma_f32_32x32x16_bf16 v[152:167], v[60:63], v[68:71], v[152:167]
    ds_read_b64_tr_b16 v[60:61], v5 offset:3072
    ds_read_b64_tr_b16 v[62:63], v5 offset:3328
    ds_read_b128 v[68:71], v7 offset:4096
    s_waitcnt lgkmcnt(14)
    v_mfma_f32_32x32x16_bf16 v[72:87], v[32:35], v[44:47], v[72:87]
    s_waitcnt lgkmcnt(8)
    v_readfirstlane_b32 s4, v11
    v_add_u32 v7, 45056, v7
    v_mfma_f32_32x32x16_bf16 v[88:103], v[36:39], v[44:47], v[88:103]
    s_cmp_lt_u32 s4, 16
    s_cbranch_scc1 Lgs93
Lgr94:
    v_mfma_f32_32x32x16_bf16 v[104:119], v[40:43], v[44:47], v[104:119]
    ds_read_b128 v[44:47], v8 offset:0
    v_mfma_f32_32x32x16_bf16 v[120:135], v[32:35], v[48:51], v[120:135]
    ds_read_b64_tr_b16 v[32:33], v3 offset:6144
    ds_read_b64_tr_b16 v[34:35], v3 offset:6400
    v_mfma_f32_32x32x16_bf16 v[136:151], v[36:39], v[48:51], v[136:151]
    ds_read_b64_tr_b16 v[36:37], v4 offset:6144
    ds_read_b64_tr_b16 v[38:39], v4 offset:6400
    v_mfma_f32_32x32x16_bf16 v[152:167], v[40:43], v[48:51], v[152:167]
    ds_read_b64_tr_b16 v[40:41], v5 offset:6144
    ds_read_b64_tr_b16 v[42:43], v5 offset:6400
    ds_read_b128 v[48:51], v8 offset:4096
    s_waitcnt lgkmcnt(13)
    v_mfma_f32_32x32x16_bf16 v[72:87], v[52:55], v[64:67], v[72:87]
    ds_read_b32 v11, v2 offset:0
    v_add_u32 v8, 45056, v8
    s_waitcnt lgkmcnt(12)
    v_mfma_f32_32x32x16_bf16 v[88:103], v[56:59], v[64:67], v[88:103]
    s_waitcnt lgkmcnt(10)
    v_mfma_f32_32x32x16_bf16 v[104:119], v[60:63], v[64:67], v[104:119]
    ds_read_b128 v[64:67], v9 offset:0
    s_waitcnt lgkmcnt(10)
    v_mfma_f32_32x32x16_bf16 v[120:135], v[52:55], v[68:71], v[120:135]
    ds_read_b64_tr_b16 v[52:53], v3 offset:9216
    ds_read_b64_tr_b16 v[54:55], v3 offset:9472
    v_mfma_f32_32x32x16_bf16 v[136:151], v[56:59], v[68:71], v[136:151]
    ds_read_b64_tr_b16 v[56:57], v4 offset:9216
    ds_read_b64_tr_b16 v[58:59], v4 offset:9472
    v_mfma_f32_32x32x16_bf16 v[152:167], v[60:63], v[68:71], v[152:167]
    ds_read_b64_tr_b16 v[60:61], v5 offset:9216
    ds_read_b64_tr_b16 v[62:63], v5 offset:9472
    ds_read_b128 v[68:71], v9 offset:4096
    s_waitcnt lgkmcnt(14)
    v_mfma_f32_32x32x16_bf16 v[72:87], v[32:35], v[44:47], v[72:87]
    s_waitcnt lgkmcnt(8)
    v_readfirstlane_b32 s4, v11
    v_add_u32 v9, 45056, v9
    v_mov_b32 v14, 4
    ds_write_b32 v10, v14 offset:16
    v_mfma_f32_32x32x16_bf16 v[88:103], v[36:39], v[44:47], v[88:103]
    s_cmp_lt_u32 s4, 18
    s_cbranch_scc1 Lgs97
Lgr98:
    v_add_u32 v3, 45056, v3
    v_add_u32 v4, 45056, v4
    v_add_u32 v5, 45056, v5
    v_mfma_f32_32x32x16_bf16 v[104:119], v[40:43], v[44:47], v[104:119]
    ds_read_b128 v[44:47], v6 offset:0
    v_mfma_f32_32x32x16_bf16 v[120:135], v[32:35], v[48:51], v[120:135]
    ds_read_b64_tr_b16 v[32:33], v3 offset:0
    ds_read_b64_tr_b16 v[34:35], v3 offset:256
    v_mfma_f32_32x32x16_bf16 v[136:151], v[36:39], v[48:51], v[136:151]
    ds_read_b64_tr_b16 v[36:37], v4 offset:0
    ds_read_b64_tr_b16 v[38:39], v4 offset:256
    v_mfma_f32_32x32x16_bf16 v[152:167], v[40:43], v[48:51], v[152:167]
    ds_read_b64_tr_b16 v[40:41], v5 offset:0
    ds_read_b64_tr_b16 v[42:43], v5 offset:256
    ds_read_b128 v[48:51], v6 offset:4096
    s_waitcnt lgkmcnt(14)
    v_mfma_f32_32x32x16_bf16 v[72:87], v[52:55], v[64:67], v[72:87]
    ds_read_b32 v11, v2 offset:0
    v_add_u32 v6, 45056, v6
    s_waitcnt lgkmcnt(13)
    v_mfma_f32_32x32x16_bf16 v[88:103], v[56:59], v[64:67], v[88:103]
    s_waitcnt lgkmcnt(11)
    v_mfma_f32_32x32x16_bf16 v[104:119], v[60:63], v[64:67], v[104:119]
    ds_read_b128 v[64:67], v7 offset:0
    s_waitcnt lgkmcnt(11)
    v_mfma_f32_32x32x16_bf16 v[120:135], v[52:55], v[68:71], v[120:135]
    ds_read_b64_tr_b16 v[52:53], v3 offset:3072
    ds_read_b64_tr_b16 v[54:55], v3 offset:3328
    v_mfma_f32_32x32x16_bf16 v[136:151], v[56:59], v[68:71], v[136:151]
    ds_read_b64_tr_b16 v[56:57], v4 offset:3072
    ds_read_b64_tr_b16 v[58:59], v4 offset:3328
    v_mfma_f32_32x32x16_bf16 v[152:167], v[60:63], v[68:71], v[152:167]
    ds_read_b64_tr_b16 v[60:61], v5 offset:3072
    ds_read_b64_tr_b16 v[62:63], v5 offset:3328
    ds_read_b128 v[68:71], v7 offset:4096
    s_waitcnt lgkmcnt(14)
    v_mfma_f32_32x32x16_bf16 v[72:87], v[32:35], v[44:47], v[72:87]
    s_waitcnt lgkmcnt(8)
    v_readfirstlane_b32 s4, v11
    v_add_u32 v7, 45056, v7
    v_mfma_f32_32x32x16_bf16 v[88:103], v[36:39], v[44:47], v[88:103]
    s_cmp_lt_u32 s4, 20
    s_cbranch_scc1 Lgs101
Lgr102:
    v_mfma_f32_32x32x16_bf16 v[104:119], v[40:43], v[44:47], v[104:119]
    ds_read_b128 v[44:47], v8 offset:0
    v_mfma_f32_32x32x16_bf16 v[120:135], v[32:35], v[48:51], v[120:135]
    ds_read_b64_tr_b16 v[32:33], v3 offset:6144
    ds_read_b64_tr_b16 v[34:35], v3 offset:6400
    v_mfma_f32_32x32x16_bf16 v[136:151], v[36:39], v[48:51], v[136:151]
    ds_read_b64_tr_b16 v[36:37], v4 offset:6144
    ds_read_b64_tr_b16 v[38:39], v4 offset:6400
    v_mfma_f32_32x32x16_bf16 v[152:167], v[40:43], v[48:51], v[152:167]
    ds_read_b64_tr_b16 v[40:41], v5 offset:6144
    ds_read_b64_tr_b16 v[42:43], v5 offset:6400
    ds_read_b128 v[48:51], v8 offset:4096
    s_waitcnt lgkmcnt(13)
    v_mfma_f32_32x32x16_bf16 v[72:87], v[52:55], v[64:67], v[72:87]
    ds_read_b32 v11, v2 offset:0
    v_add_u32 v8, 45056, v8
    s_waitcnt lgkmcnt(12)
    v_mfma_f32_32x32x16_bf16 v[88:103], v[56:59], v[64:67], v[88:103]
    s_waitcnt lgkmcnt(10)
    v_mfma_f32_32x32x16_bf16 v[104:119], v[60:63], v[64:67], v[104:119]
    ds_read_b128 v[64:67], v9 offset:0
    s_waitcnt lgkmcnt(10)
    v_mfma_f32_32x32x16_bf16 v[120:135], v[52:55], v[68:71], v[120:135]
    ds_read_b64_tr_b16 v[52:53], v3 offset:9216
    ds_read_b64_tr_b16 v[54:55], v3 offset:9472
    v_mfma_f32_32x32x16_bf16 v[136:151], v[56:59], v[68:71], v[136:151]
    ds_read_b64_tr_b16 v[56:57], v4 offset:9216
    ds_read_b64_tr_b16 v[58:59], v4 offset:9472
    v_mfma_f32_32x32x16_bf16 v[152:167], v[60:63], v[68:71], v[152:167]
    ds_read_b64_tr_b16 v[60:61], v5 offset:9216
    ds_read_b64_tr_b16 v[62:63], v5 offset:9472
    ds_read_b128 v[68:71], v9 offset:4096
    s_waitcnt lgkmcnt(14)
    v_mfma_f32_32x32x16_bf16 v[72:87], v[32:35], v[44:47], v[72:87]
    s_waitcnt lgkmcnt(8)
    v_readfirstlane_b32 s4, v11
    v_add_u32 v9, 45056, v9
    v_mov_b32 v14, 5
    ds_write_b32 v10, v14 offset:16
    v_mfma_f32_32x32x16_bf16 v[88:103], v[36:39], v[44:47], v[88:103]
    s_cmp_lt_u32 s4, 22
    s_cbranch_scc1 Lgs105
Lgr106:
    v_add_u32 v3, 45056, v3
    v_add_u32 v4, 45056, v4
    v_add_u32 v5, 45056, v5
    v_mfma_f32_32x32x16_bf16 v[104:119], v[40:43], v[44:47], v[104:119]
    ds_read_b128 v[44:47], v6 offset:0
    v_mfma_f32_32x32x16_bf16 v[120:135], v[32:35], v[48:51], v[120:135]
    ds_read_b64_tr_b16 v[32:33], v3 offset:0
    ds_read_b64_tr_b16 v[34:35], v3 offset:256
    v_mfma_f32_32x32x16_bf16 v[136:151], v[36:39], v[48:51], v[136:151]
    ds_read_b64_tr_b16 v[36:37], v4 offset:0
    ds_read_b64_tr_b16 v[38:39], v4 offset:256
    v_mfma_f32_32x32x16_bf16 v[152:167], v[40:43], v[48:51], v[152:167]
    ds_read_b64_tr_b16 v[40:41], v5 offset:0
    ds_read_b64_tr_b16 v[42:43], v5 offset:256
    ds_read_b128 v[48:51], v6 offset:4096
    s_waitcnt lgkmcnt(14)
    v_mfma_f32_32x32x16_bf16 v[72:87], v[52:55], v[64:67], v[72:87]
    ds_read_b32 v11, v2 offset:0
    v_subrev_u32 v6, 90112, v6
    s_waitcnt lgkmcnt(13)
    v_mfma_f32_32x32x16_bf16 v[88:103], v[56:59], v[64:67], v[88:103]
    s_waitcnt lgkmcnt(11)
    v_mfma_f32_32x32x16_bf16 v[104:119], v[60:63], v[64:67], v[104:119]
    ds_read_b128 v[64:67], v7 offset:0
    s_waitcnt lgkmcnt(11)
    v_mfma_f32_32x32x16_bf16 v[120:135], v[52:55], v[68:71], v[120:135]
    ds_read_b64_tr_b16 v[52:53], v3 offset:3072
    ds_read_b64_tr_b16 v[54:55], v3 offset:3328
    v_mfma_f32_32x32x16_bf16 v[136:151], v[56:59], v[68:71], v[136:151]
    ds_read_b64_tr_b16 v[56:57], v4 offset:3072
    ds_read_b64_tr_b16 v[58:59], v4 offset:3328
    v_mfma_f32_32x32x16_bf16 v[152:167], v[60:63], v[68:71], v[152:167]
    ds_read_b64_tr_b16 v[60:61], v5 offset:3072
    ds_read_b64_tr_b16 v[62:63], v5 offset:3328
    ds_read_b128 v[68:71], v7 offset:4096
    s_waitcnt lgkmcnt(14)
    v_mfma_f32_32x32x16_bf16 v[72:87], v[32:35], v[44:47], v[72:87]
    s_waitcnt lgkmcnt(8)
    v_readfirstlane_b32 s4, v11
    v_subrev_u32 v7, 90112, v7
    v_mfma_f32_32x32x16_bf16 v[88:103], v[36:39], v[44:47], v[88:103]
    s_cmp_lt_u32 s4, 24
    s_cbranch_scc1 Lgs109
Lgr110:
    v_mfma_f32_32x32x16_bf16 v[104:119], v[40:43], v[44:47], v[104:119]
    ds_read_b128 v[44:47], v8 offset:0
    v_mfma_f32_32x32x16_bf16 v[120:135], v[32:35], v[48:51], v[120:135]
    ds_read_b64_tr_b16 v[32:33], v3 offset:6144
    ds_read_b64_tr_b16 v[34:35], v3 offset:6400
    v_mfma_f32_32x32x16_bf16 v[136:151], v[36:39], v[48:51], v[136:151]
    ds_read_b64_tr_b16 v[36:37], v4 offset:6144
    ds_read_b64_tr_b16 v[38:39], v4 offset:6400
    v_mfma_f32_32x32x16_bf16 v[152:167], v[40:43], v[48:51], v[152:167]
    ds_read_b64_tr_b16 v[40:41], v5 offset:6144
    ds_read_b64_tr_b16 v[42:43], v5 offset:6400
    ds_read_b128 v[48:51], v8 offset:4096
    s_waitcnt lgkmcnt(13)
    v_mfma_f32_32x32x16_bf16 v[72:87], v[52:55], v[64:67], v[72:87]
    ds_read_b32 v11, v2 offset:0
    v_subrev_u32 v8, 90112, v8
    s_waitcnt lgkmcnt(12)
    v_mfma_f32_32x32x16_bf16 v[88:103], v[56:59], v[64:67], v[88:103]
    s_waitcnt lgkmcnt(10)
    v_mfma_f32_32x32x16_bf16 v[104:119], v[60:63], v[64:67], v[104:119]
    ds_read_b128 v[64:67], v9 offset:0
    s_waitcnt lgkmcnt(10)
    v_mfma_f32_32x32x16_bf16 v[120:135], v[52:55], v[68:71], v[120:135]
    ds_read_b64_tr_b16 v[52:53], v3 offset:9216
    ds_read_b64_tr_b16 v[54:55], v3 offset:9472
    v_mfma_f32_32x32x16_bf16 v[136:151], v[56:59], v[68:71], v[136:151]
    ds_read_b64_tr_b16 v[56:57], v4 offset:9216
    ds_read_b64_tr_b16 v[58:59], v4 offset:9472
    v_mfma_f32_32x32x16_bf16 v[152:167], v[60:63], v[68:71], v[152:167]
    ds_read_b64_tr_b16 v[60:61], v5 offset:9216
    ds_read_b64_tr_b16 v[62:63], v5 offset:9472
    ds_read_b128 v[68:71], v9 offset:4096
    s_waitcnt lgkmcnt(14)
    v_mfma_f32_32x32x16_bf16 v[72:87], v[32:35], v[44:47], v[72:87]
    s_waitcnt lgkmcnt(8)
    v_readfirstlane_b32 s4, v11
    v_subrev_u32 v9, 90112, v9
    v_mov_b32 v14, 6
    ds_write_b32 v10, v14 offset:16
    v_mfma_f32_32x32x16_bf16 v[88:103], v[36:39], v[44:47], v[88:103]
    s_cmp_lt_u32 s4, 26
    s_cbranch_scc1 Lgs113
Lgr114:
    v_subrev_u32 v3, 90112, v3
    v_subrev_u32 v4, 90112, v4
    v_subrev_u32 v5, 90112, v5
    v_mfma_f32_32x32x16_bf16 v[104:119], v[40:43], v[44:47], v[104:119]
    ds_read_b128 v[44:47], v6 offset:0
    v_mfma_f32_32x32x16_bf16 v[120:135], v[32:35], v[48:51], v[120:135]
    ds_read_b64_tr_b16 v[32:33], v3 offset:0
    ds_read_b64_tr_b16 v[34:35], v3 offset:256
    v_mfma_f32_32x32x16_bf16 v[136:151], v[36:39], v[48:51], v[136:151]
    ds_read_b64_tr_b16 v[36:37], v4 offset:0
    ds_read_b64_tr_b16 v[38:39], v4 offset:256
    v_mfma_f32_32x32x16_bf16 v[152:167], v[40:43], v[48:51], v[152:167]
    ds_read_b64_tr_b16 v[40:41], v5 offset:0
    ds_read_b64_tr_b16 v[42:43], v5 offset:256
    ds_read_b128 v[48:51], v6 offset:4096
    s_waitcnt lgkmcnt(14)
    v_mfma_f32_32x32x16_bf16 v[72:87], v[52:55], v[64:67], v[72:87]
    ds_read_b32 v11, v2 offset:0
    v_add_u32 v6, 45056, v6
    s_waitcnt lgkmcnt(13)
    v_mfma_f32_32x32x16_bf16 v[88:103], v[56:59], v[64:67], v[88:103]
    s_waitcnt lgkmcnt(11)
    v_mfma_f32_32x32x16_bf16 v[104:119], v[60:63], v[64:67], v[104:119]
    ds_read_b128 v[64:67], v7 offset:0
    s_waitcnt lgkmcnt(11)
    v_mfma_f32_32x32x16_bf16 v[120:135], v[52:55], v[68:71], v[120:135]
    ds_read_b64_tr_b16 v[52:53], v3 offset:3072
    ds_read_b64_tr_b16 v[54:55], v3 offset:3328
    v_mfma_f32_32x32x16_bf16 v[136:151], v[56:59], v[68:71], v[136:151]
    ds_read_b64_tr_b16 v[56:57], v4 offset:3072
    ds_read_b64_tr_b16 v[58:59], v4 offset:3328
    v_mfma_f32_32x32x16_bf16 v[152:167], v[60:63], v[68:71], v[152:167]
    ds_read_b64_tr_b16 v[60:61], v5 offset:3072
    ds_read_b64_tr_b16 v[62:63], v5 offset:3328
    ds_read_b128 v[68:71], v7 offset:4096
    s_waitcnt lgkmcnt(14)
    v_mfma_f32_32x32x16_bf16 v[72:87], v[32:35], v[44:47], v[72:87]
    s_waitcnt lgkmcnt(8)
    v_readfirstlane_b32 s4, v11
    v_add_u32 v7, 45056, v7
    v_mfma_f32_32x32x16_bf16 v[88:103], v[36:39], v[44:47], v[88:103]
    s_cmp_lt_u32 s4, 28
    s_cbranch_scc1 Lgs117
Lgr118:
    v_mfma_f32_32x32x16_bf16 v[104:119], v[40:43], v[44:47], v[104:119]
    ds_read_b128 v[44:47], v8 offset:0
    v_mfma_f32_32x32x16_bf16 v[120:135], v[32:35], v[48:51], v[120:135]
    ds_read_b64_tr_b16 v[32:33], v3 offset:6144
    ds_read_b64_tr_b16 v[34:35], v3 offset:6400
    v_mfma_f32_32x32x16_bf16 v[136:151], v[36:39], v[48:51], v[136:151]
    ds_read_b64_tr_b16 v[36:37], v4 offset:6144
    ds_read_b64_tr_b16 v[38:39], v4 offset:6400
    v_mfma_f32_32x32x16_bf16 v[152:167], v[40:43], v[48:51], v[152:167]
    ds_read_b64_tr_b16 v[40:41], v5 offset:6144
    ds_read_b64_tr_b16 v[42:43], v5 offset:6400
    ds_read_b128 v[48:51], v8 offset:4096
    s_waitcnt lgkmcnt(13)
    v_mfma_f32_32x32x16_bf16 v[72:87], v[52:55], v[64:67], v[72:87]
    ds_read_b32 v11, v2 offset:0
    v_add_u32 v8, 45056, v8
    s_waitcnt lgkmcnt(12)
    v_mfma_f32_32x32x16_bf16 v[88:103], v[56:59], v[64:67], v[88:103]
    s_waitcnt lgkmcnt(10)
    v_mfma_f32_32x32x16_bf16 v[104:119], v[60:63], v[64:67], v[104:119]
    ds_read_b128 v[64:67], v9 offset:0
    s_waitcnt lgkmcnt(10)
    v_mfma_f32_32x32x16_bf16 v[120:135], v[52:55], v[68:71], v[120:135]
    ds_read_b64_tr_b16 v[52:53], v3 offset:9216
    ds_read_b64_tr_b16 v[54:55], v3 offset:9472
    v_mfma_f32_32x32x16_bf16 v[136:151], v[56:59], v[68:71], v[136:151]
    ds_read_b64_tr_b16 v[56:57], v4 offset:9216
    ds_read_b64_tr_b16 v[58:59], v4 offset:9472
    v_mfma_f32_32x32x16_bf16 v[152:167], v[60:63], v[68:71], v[152:167]
    ds_read_b64_tr_b16 v[60:61], v5 offset:9216
    ds_read_b64_tr_b16 v[62:63], v5 offset:9472
    ds_read_b128 v[68:71], v9 offset:4096
    s_waitcnt lgkmcnt(14)
    v_mfma_f32_32x32x16_bf16 v[72:87], v[32:35], v[44:47], v[72:87]
    s_waitcnt lgkmcnt(8)
    v_readfirstlane_b32 s4, v11
    v_add_u32 v9, 45056, v9
    v_mov_b32 v14, 7
    ds_write_b32 v10, v14 offset:16
    v_mfma_f32_32x32x16_bf16 v[88:103], v[36:39], v[44:47], v[88:103]
    s_cmp_lt_u32 s4, 30
    s_cbranch_scc1 Lgs121
Lgr122:
    v_add_u32 v3, 45056, v3
    v_add_u32 v4, 45056, v4
    v_add_u32 v5, 45056, v5
    v_mfma_f32_32x32x16_bf16 v[104:119], v[40:43], v[44:47], v[104:119]
    ds_read_b128 v[44:47], v6 offset:0
    v_mfma_f32_32x32x16_bf16 v[120:135], v[32:35], v[48:51], v[120:135]
    ds_read_b64_tr_b16 v[32:33], v3 offset:0
    ds_read_b64_tr_b16 v[34:35], v3 offset:256
    v_mfma_f32_32x32x16_bf16 v[136:151], v[36:39], v[48:51], v[136:151]
    ds_read_b64_tr_b16 v[36:37], v4 offset:0
    ds_read_b64_tr_b16 v[38:39], v4 offset:256
    v_mfma_f32_32x32x16_bf16 v[152:167], v[40:43], v[48:51], v[152:167]
    ds_read_b64_tr_b16 v[40:41], v5 offset:0
    ds_read_b64_tr_b16 v[42:43], v5 offset:256
    ds_read_b128 v[48:51], v6 offset:4096
    s_waitcnt lgkmcnt(14)
    v_mfma_f32_32x32x16_bf16 v[72:87], v[52:55], v[64:67], v[72:87]
    ds_read_b32 v11, v2 offset:0
    s_waitcnt lgkmcnt(13)
    v_mfma_f32_32x32x16_bf16 v[88:103], v[56:59], v[64:67], v[88:103]
    s_waitcnt lgkmcnt(11)
    v_mfma_f32_32x32x16_bf16 v[104:119], v[60:63], v[64:67], v[104:119]
    ds_read_b128 v[64:67], v7 offset:0
    s_waitcnt lgkmcnt(11)
    v_mfma_f32_32x32x16_bf16 v[120:135], v[52:55], v[68:71], v[120:135]
    ds_read_b64_tr_b16 v[52:53], v3 offset:3072
    ds_read_b64_tr_b16 v[54:55], v3 offset:3328
    v_mfma_f32_32x32x16_bf16 v[136:151], v[56:59], v[68:71], v[136:151]
    ds_read_b64_tr_b16 v[56:57], v4 offset:3072
    ds_read_b64_tr_b16 v[58:59], v4 offset:3328
    v_mfma_f32_32x32x16_bf16 v[152:167], v[60:63], v[68:71], v[152:167]
    ds_read_b64_tr_b16 v[60:61], v5 offset:3072
    ds_read_b64_tr_b16 v[62:63], v5 offset:3328
    ds_read_b128 v[68:71], v7 offset:4096
    s_waitcnt lgkmcnt(14)
    v_mfma_f32_32x32x16_bf16 v[72:87], v[32:35], v[44:47], v[72:87]
    s_waitcnt lgkmcnt(8)
    v_readfirstlane_b32 s4, v11
    v_mfma_f32_32x32x16_bf16 v[88:103], v[36:39], v[44:47], v[88:103]
    s_cmp_lt_u32 s4, 32
    s_cbranch_scc1 Lgs125
Lgr126:
    v_mfma_f32_32x32x16_bf16 v[104:119], v[40:43], v[44:47], v[104:119]
    ds_read_b128 v[44:47], v8 offset:0
    v_mfma_f32_32x32x16_bf16 v[120:135], v[32:35], v[48:51], v[120:135]
    ds_read_b64_tr_b16 v[32:33], v3 offset:6144
    ds_read_b64_tr_b16 v[34:35], v3 offset:6400
    v_mfma_f32_32x32x16_bf16 v[136:151], v[36:39], v[48:51], v[136:151]
    ds_read_b64_tr_b16 v[36:37], v4 offset:6144
    ds_read_b64_tr_b16 v[38:39], v4 offset:6400
    v_mfma_f32_32x32x16_bf16 v[152:167], v[40:43], v[48:51], v[152:167]
    ds_read_b64_tr_b16 v[40:41], v5 offset:6144
    ds_read_b64_tr_b16 v[42:43], v5 offset:6400
    ds_read_b128 v[48:51], v8 offset:4096
    s_waitcnt lgkmcnt(13)
    v_mfma_f32_32x32x16_bf16 v[72:87], v[52:55], v[64:67], v[72:87]
    ds_read_b32 v11, v2 offset:32
    s_waitcnt lgkmcnt(12)
    v_mfma_f32_32x32x16_bf16 v[88:103], v[56:59], v[64:67], v[88:103]
    v_and_b32 v13, 31, v1
    s_lshl_b32 s8, s14, 8
    s_add_u32 s8, s8, 162816
    v_lshl_add_u32 v15, v13, 2, s8
    s_waitcnt lgkmcnt(10)
    v_mfma_f32_32x32x16_bf16 v[104:119], v[60:63], v[64:67], v[104:119]
    ds_read_b128 v[64:67], v9 offset:0
    s_waitcnt lgkmcnt(10)
    v_mfma_f32_32x32x16_bf16 v[120:135], v[52:55], v[68:71], v[120:135]
    ds_read_b64_tr_b16 v[52:53], v3 offset:9216
    ds_read_b64_tr_b16 v[54:55], v3 offset:9472
    v_mfma_f32_32x32x16_bf16 v[136:151], v[56:59], v[68:71], v[136:151]
    ds_read_b64_tr_b16 v[56:57], v4 offset:9216
    ds_read_b64_tr_b16 v[58:59], v4 offset:9472
    v_mfma_f32_32x32x16_bf16 v[152:167], v[60:63], v[68:71], v[152:167]
    ds_read_b64_tr_b16 v[60:61], v5 offset:9216
    ds_read_b64_tr_b16 v[62:63], v5 offset:9472
    ds_read_b128 v[68:71], v9 offset:4096
    s_waitcnt lgkmcnt(14)
    v_mfma_f32_32x32x16_bf16 v[72:87], v[32:35], v[44:47], v[72:87]
    v_mov_b32 v14, 8
    ds_write_b32 v10, v14 offset:16
    s_waitcnt lgkmcnt(13)
    v_mfma_f32_32x32x16_bf16 v[88:103], v[36:39], v[44:47], v[88:103]
    s_waitcnt lgkmcnt(9)
    v_readfirstlane_b32 s4, v11
    v_mfma_f32_32x32x16_bf16 v[104:119], v[40:43], v[44:47], v[104:119]
    s_cmp_lt_u32 s4, 1
    s_cbranch_scc1 Lgs129
Lgr130:
    ds_read2_b32 v[30:31], v15 offset0:0 offset1:32
    s_mul_i32 s8, s15, 768
    s_add_u32 s8, s8, 161280
    v_lshl_add_u32 v13, v13, 3, s8
    v_mfma_f32_32x32x16_bf16 v[120:135], v[32:35], v[48:51], v[120:135]
    ds_read_b64 v[24:25], v13 offset:0
    ds_read_b64 v[26:27], v13 offset:256
    ds_read_b64 v[28:29], v13 offset:512
    v_cmp_gt_u32 vcc, 32, v1
    v_mfma_f32_32x32x16_bf16 v[136:151], v[36:39], v[48:51], v[136:151]
    v_mfma_f32_32x32x16_bf16 v[152:167], v[40:43], v[48:51], v[152:167]
    s_waitcnt lgkmcnt(10)
    v_mfma_f32_32x32x16_bf16 v[72:87], v[52:55], v[64:67], v[72:87]
    s_waitcnt lgkmcnt(0)
    v_and_b32 v18, 0xffff0000, v30
    v_and_b32 v30, 0xffff, v30
    v_xor_b32 v30, 0x8000, v30
    v_rcp_f32 v16, v18
    v_mfma_f32_32x32x16_bf16 v[88:103], v[56:59], v[64:67], v[88:103]
    v_lshl_or_b32 v20, v30, 16, v30
    v_cndmask_b32 v21, 0, v30, vcc
    v_cndmask_b32 v20, 0, v20, vcc
    v_mul_f32 v18, v18, v18
    v_mul_f32 v16, 0xbfb8aa3b, v16
    v_mfma_f32_32x32x16_bf16 v[104:119], v[60:63], v[64:67], v[104:119]
    v_and_b32 v19, 0xffff0000, v31
    v_and_b32 v31, 0xffff, v31
    v_xor_b32 v31, 0x8000, v31
    v_rcp_f32 v17, v19
    v_mfma_f32_32x32x16_bf16 v[120:135], v[52:55], v[68:71], v[120:135]
    v_lshl_or_b32 v22, v31, 16, v31
    v_cndmask_b32 v23, 0, v31, vcc
    v_cndmask_b32 v22, 0, v22, vcc
    v_mul_f32 v19, v19, v19
    v_mul_f32 v17, 0xbfb8aa3b, v17
    v_mfma_f32_32x32x16_bf16 v[136:151], v[56:59], v[68:71], v[136:151]
    v_mfma_f32_32x32x16_bf16 v[152:167], v[60:63], v[68:71], v[152:167]
    v_mfma_f32_32x32x8_bf16 v[72:87], v[24:25], v[20:21], v[72:87]
    v_mfma_f32_32x32x8_bf16 v[120:135], v[24:25], v[22:23], v[120:135]
    v_mfma_f32_32x32x8_bf16 v[88:103], v[26:27], v[20:21], v[88:103]
    v_mfma_f32_32x32x8_bf16 v[136:151], v[26:27], v[22:23], v[136:151]
    v_mfma_f32_32x32x8_bf16 v[104:119], v[28:29], v[20:21], v[104:119]
    v_mfma_f32_32x32x8_bf16 v[152:167], v[28:29], v[22:23], v[152:167]
    s_nop 6
    v_pk_mul_f32 v[80:81], v[72:73], v[80:81]
    v_pk_mul_f32 v[82:83], v[74:75], v[82:83]
    v_pk_mul_f32 v[84:85], v[76:77], v[84:85]
    v_pk_mul_f32 v[86:87], v[78:79], v[86:87]
    v_pk_mul_f32 v[72:73], v[72:73], v[16:17] op_sel_hi:[1,0]
    v_pk_mul_f32 v[74:75], v[74:75], v[16:17] op_sel_hi:[1,0]
    v_pk_mul_f32 v[76:77], v[76:77], v[16:17] op_sel_hi:[1,0]
    v_pk_mul_f32 v[78:79], v[78:79], v[16:17] op_sel_hi:[1,0]
    v_exp_f32 v72, v72
    v_exp_f32 v73, v73
    v_exp_f32 v74, v74
    v_exp_f32 v75, v75
    v_exp_f32 v76, v76
    v_exp_f32 v77, v77
    v_exp_f32 v78, v78
    v_exp_f32 v79, v79
    v_pk_fma_f32 v[72:73], v[72:73], v[18:19], v[18:19] op_sel_hi:[1,0,0]
    v_pk_fma_f32 v[74:75], v[74:75], v[18:19], v[18:19] op_sel_hi:[1,0,0]
    v_pk_fma_f32 v[76:77], v[76:77], v[18:19], v[18:19] op_sel_hi:[1,0,0]
    v_pk_fma_f32 v[78:79], v[78:79], v[18:19], v[18:19] op_sel_hi:[1,0,0]
    v_rcp_f32 v72, v72
    v_rcp_f32 v73, v73
    v_rcp_f32 v74, v74
    v_rcp_f32 v75, v75
    v_rcp_f32 v76, v76
    v_rcp_f32 v77, v77
    v_rcp_f32 v78, v78
    v_rcp_f32 v79, v79
    v_pk_mul_f32 v[80:81], v[80:81], v[72:73]
    v_pk_mul_f32 v[82:83], v[82:83], v[74:75]
    v_pk_mul_f32 v[84:85], v[84:85], v[76:77]
    v_pk_mul_f32 v[86:87], v[86:87], v[78:79]
    v_cvt_pk_bf16_f32 v72, v80, v81
    v_cvt_pk_bf16_f32 v73, v82, v83
    v_cvt_pk_bf16_f32 v74, v84, v85
    v_cvt_pk_bf16_f32 v75, v86, v87
    buffer_store_dwordx4 v[72:75], v12, s[64:67], s76 offen offset:0 sc1
    v_pk_mul_f32 v[128:129], v[120:121], v[128:129]
    v_pk_mul_f32 v[130:131], v[122:123], v[130:131]
    v_pk_mul_f32 v[132:133], v[124:125], v[132:133]
    v_pk_mul_f32 v[134:135], v[126:127], v[134:135]
    v_pk_mul_f32 v[120:121], v[120:121], v[16:17] op_sel:[0,1]
    v_pk_mul_f32 v[122:123], v[122:123], v[16:17] op_sel:[0,1]
    v_pk_mul_f32 v[124:125], v[124:125], v[16:17] op_sel:[0,1]
    v_pk_mul_f32 v[126:127], v[126:127], v[16:17] op_sel:[0,1]
    v_exp_f32 v120, v120
    v_exp_f32 v121, v121
    v_exp_f32 v122, v122
    v_exp_f32 v123, v123
    v_exp_f32 v124, v124
    v_exp_f32 v125, v125
    v_exp_f32 v126, v126
    v_exp_f32 v127, v127
    v_pk_fma_f32 v[120:121], v[120:121], v[18:19], v[18:19] op_sel:[0,1,1]
    v_pk_fma_f32 v[122:123], v[122:123], v[18:19], v[18:19] op_sel:[0,1,1]
    v_pk_fma_f32 v[124:125], v[124:125], v[18:19], v[18:19] op_sel:[0,1,1]
    v_pk_fma_f32 v[126:127], v[126:127], v[18:19], v[18:19] op_sel:[0,1,1]
    v_rcp_f32 v120, v120
    v_rcp_f32 v121, v121
    v_rcp_f32 v122, v122
    v_rcp_f32 v123, v123
    v_rcp_f32 v124, v124
    v_rcp_f32 v125, v125
    v_rcp_f32 v126, v126
    v_rcp_f32 v127, v127
    v_pk_mul_f32 v[128:129], v[128:129], v[120:121]
    v_pk_mul_f32 v[130:131], v[130:131], v[122:123]
    v_pk_mul_f32 v[132:133], v[132:133], v[124:125]
    v_pk_mul_f32 v[134:135], v[134:135], v[126:127]
    v_cvt_pk_bf16_f32 v120, v128, v129
    v_cvt_pk_bf16_f32 v121, v130, v131
    v_cvt_pk_bf16_f32 v122, v132, v133
    v_cvt_pk_bf16_f32 v123, v134, v135
    buffer_store_dwordx4 v[120:123], v12, s[64:67], s77 offen offset:0 sc1
    v_pk_mul_f32 v[96:97], v[88:89], v[96:97]
    v_pk_mul_f32 v[98:99], v[90:91], v[98:99]
    v_pk_mul_f32 v[100:101], v[92:93], v[100:101]
    v_pk_mul_f32 v[102:103], v[94:95], v[102:103]
    v_pk_mul_f32 v[88:89], v[88:89], v[16:17] op_sel_hi:[1,0]
    v_pk_mul_f32 v[90:91], v[90:91], v[16:17] op_sel_hi:[1,0]
    v_pk_mul_f32 v[92:93], v[92:93], v[16:17] op_sel_hi:[1,0]
    v_pk_mul_f32 v[94:95], v[94:95], v[16:17] op_sel_hi:[1,0]
    v_exp_f32 v88, v88
    v_exp_f32 v89, v89
    v_exp_f32 v90, v90
    v_exp_f32 v91, v91
    v_exp_f32 v92, v92
    v_exp_f32 v93, v93
    v_exp_f32 v94, v94
    v_exp_f32 v95, v95
    v_pk_fma_f32 v[88:89], v[88:89], v[18:19], v[18:19] op_sel_hi:[1,0,0]
    v_pk_fma_f32 v[90:91], v[90:91], v[18:19], v[18:19] op_sel_hi:[1,0,0]
    v_pk_fma_f32 v[92:93], v[92:93], v[18:19], v[18:19] op_sel_hi:[1,0,0]
    v_pk_fma_f32 v[94:95], v[94:95], v[18:19], v[18:19] op_sel_hi:[1,0,0]
    v_rcp_f32 v88, v88
    v_rcp_f32 v89, v89
    v_rcp_f32 v90, v90
    v_rcp_f32 v91, v91
    v_rcp_f32 v92, v92
    v_rcp_f32 v93, v93
    v_rcp_f32 v94, v94
    v_rcp_f32 v95, v95
    v_pk_mul_f32 v[96:97], v[96:97], v[88:89]
    v_pk_mul_f32 v[98:99], v[98:99], v[90:91]
    v_pk_mul_f32 v[100:101], v[100:101], v[92:93]
    v_pk_mul_f32 v[102:103], v[102:103], v[94:95]
    v_cvt_pk_bf16_f32 v88, v96, v97
    v_cvt_pk_bf16_f32 v89, v98, v99
    v_cvt_pk_bf16_f32 v90, v100, v101
    v_cvt_pk_bf16_f32 v91, v102, v103
    buffer_store_dwordx4 v[88:91], v12, s[64:67], s76 offen offset:1024 sc1
    v_pk_mul_f32 v[144:145], v[136:137], v[144:145]
    v_pk_mul_f32 v[146:147], v[138:139], v[146:147]
    v_pk_mul_f32 v[148:149], v[140:141], v[148:149]
    v_pk_mul_f32 v[150:151], v[142:143], v[150:151]
    v_pk_mul_f32 v[136:137], v[136:137], v[16:17] op_sel:[0,1]
    v_pk_mul_f32 v[138:139], v[138:139], v[16:17] op_sel:[0,1]
    v_pk_mul_f32 v[140:141], v[140:141], v[16:17] op_sel:[0,1]
    v_pk_mul_f32 v[142:143], v[142:143], v[16:17] op_sel:[0,1]
    v_exp_f32 v136, v136
    v_exp_f32 v137, v137
    v_exp_f32 v138, v138
    v_exp_f32 v139, v139
    v_exp_f32 v140, v140
    v_exp_f32 v141, v141
    v_exp_f32 v142, v142
    v_exp_f32 v143, v143
    v_pk_fma_f32 v[136:137], v[136:137], v[18:19], v[18:19] op_sel:[0,1,1]
    v_pk_fma_f32 v[138:139], v[138:139], v[18:19], v[18:19] op_sel:[0,1,1]
    v_pk_fma_f32 v[140:141], v[140:141], v[18:19], v[18:19] op_sel:[0,1,1]
    v_pk_fma_f32 v[142:143], v[142:143], v[18:19], v[18:19] op_sel:[0,1,1]
    v_rcp_f32 v136, v136
    v_rcp_f32 v137, v137
    v_rcp_f32 v138, v138
    v_rcp_f32 v139, v139
    v_rcp_f32 v140, v140
    v_rcp_f32 v141, v141
    v_rcp_f32 v142, v142
    v_rcp_f32 v143, v143
    v_pk_mul_f32 v[144:145], v[144:145], v[136:137]
    v_pk_mul_f32 v[146:147], v[146:147], v[138:139]
    v_pk_mul_f32 v[148:149], v[148:149], v[140:141]
    v_pk_mul_f32 v[150:151], v[150:151], v[142:143]
    v_cvt_pk_bf16_f32 v136, v144, v145
    v_cvt_pk_bf16_f32 v137, v146, v147
    v_cvt_pk_bf16_f32 v138, v148, v149
    v_cvt_pk_bf16_f32 v139, v150, v151
    buffer_store_dwordx4 v[136:139], v12, s[64:67], s77 offen offset:1024 sc1
    s_cmp_eq_u32 s74, 1
    s_cbranch_scc1 L_Gepi
    v_pk_mul_f32 v[112:113], v[104:105], v[112:113]
    v_pk_mul_f32 v[114:115], v[106:107], v[114:115]
    v_pk_mul_f32 v[116:117], v[108:109], v[116:117]
    v_pk_mul_f32 v[118:119], v[110:111], v[118:119]
    v_pk_mul_f32 v[104:105], v[104:105], v[16:17] op_sel_hi:[1,0]
    v_pk_mul_f32 v[106:107], v[106:107], v[16:17] op_sel_hi:[1,0]
    v_pk_mul_f32 v[108:109], v[108:109], v[16:17] op_sel_hi:[1,0]
    v_pk_mul_f32 v[110:111], v[110:111], v[16:17] op_sel_hi:[1,0]
    v_exp_f32 v104, v104
    v_exp_f32 v105, v105
    v_exp_f32 v106, v106
    v_exp_f32 v107, v107
    v_exp_f32 v108, v108
    v_exp_f32 v109, v109
    v_exp_f32 v110, v110
    v_exp_f32 v111, v111
    v_pk_fma_f32 v[104:105], v[104:105], v[18:19], v[18:19] op_sel_hi:[1,0,0]
    v_pk_fma_f32 v[106:107], v[106:107], v[18:19], v[18:19] op_sel_hi:[1,0,0]
    v_pk_fma_f32 v[108:109], v[108:109], v[18:19], v[18:19] op_sel_hi:[1,0,0]
    v_pk_fma_f32 v[110:111], v[110:111], v[18:19], v[18:19] op_sel_hi:[1,0,0]
    v_rcp_f32 v104, v104
    v_rcp_f32 v105, v105
    v_rcp_f32 v106, v106
    v_rcp_f32 v107, v107
    v_rcp_f32 v108, v108
    v_rcp_f32 v109, v109
    v_rcp_f32 v110, v110
    v_rcp_f32 v111, v111
    v_pk_mul_f32 v[112:113], v[112:113], v[104:105]
    v_pk_mul_f32 v[114:115], v[114:115], v[106:107]
    v_pk_mul_f32 v[116:117], v[116:117], v[108:109]
    v_pk_mul_f32 v[118:119], v[118:119], v[110:111]
    v_cvt_pk_bf16_f32 v104, v112, v113
    v_cvt_pk_bf16_f32 v105, v114, v115
    v_cvt_pk_bf16_f32 v106, v116, v117
    v_cvt_pk_bf16_f32 v107, v118, v119
    buffer_store_dwordx4 v[104:107], v12, s[64:67], s76 offen offset:2048 sc1
    v_pk_mul_f32 v[160:161], v[152:153], v[160:161]
    v_pk_mul_f32 v[162:163], v[154:155], v[162:163]
    v_pk_mul_f32 v[164:165], v[156:157], v[164:165]
    v_pk_mul_f32 v[166:167], v[158:159], v[166:167]
    v_pk_mul_f32 v[152:153], v[152:153], v[16:17] op_sel:[0,1]
    v_pk_mul_f32 v[154:155], v[154:155], v[16:17] op_sel:[0,1]
    v_pk_mul_f32 v[156:157], v[156:157], v[16:17] op_sel:[0,1]
    v_pk_mul_f32 v[158:159], v[158:159], v[16:17] op_sel:[0,1]
    v_exp_f32 v152, v152
    v_exp_f32 v153, v153
    v_exp_f32 v154, v154
    v_exp_f32 v155, v155
    v_exp_f32 v156, v156
    v_exp_f32 v157, v157
    v_exp_f32 v158, v158
    v_exp_f32 v159, v159
    v_pk_fma_f32 v[152:153], v[152:153], v[18:19], v[18:19] op_sel:[0,1,1]
    v_pk_fma_f32 v[154:155], v[154:155], v[18:19], v[18:19] op_sel:[0,1,1]
    v_pk_fma_f32 v[156:157], v[156:157], v[18:19], v[18:19] op_sel:[0,1,1]
    v_pk_fma_f32 v[158:159], v[158:159], v[18:19], v[18:19] op_sel:[0,1,1]
    v_rcp_f32 v152, v152
    v_rcp_f32 v153, v153
    v_rcp_f32 v154, v154
    v_rcp_f32 v155, v155
    v_rcp_f32 v156, v156
    v_rcp_f32 v157, v157
    v_rcp_f32 v158, v158
    v_rcp_f32 v159, v159
    v_pk_mul_f32 v[160:161], v[160:161], v[152:153]
    v_pk_mul_f32 v[162:163], v[162:163], v[154:155]
    v_pk_mul_f32 v[164:165], v[164:165], v[156:157]
    v_pk_mul_f32 v[166:167], v[166:167], v[158:159]
    v_cvt_pk_bf16_f32 v152, v160, v161
    v_cvt_pk_bf16_f32 v153, v162, v163
    v_cvt_pk_bf16_f32 v154, v164, v165
    v_cvt_pk_bf16_f32 v155, v166, v167
    buffer_store_dwordx4 v[152:155], v12, s[64:67], s77 offen offset:2048 sc1
L_Gepi:
    v_mov_b32 v14, 9
    ds_write_b32 v10, v14 offset:16
    v_lshrrev_b32 v15, 5, v1
    v_bfe_u32 v14, v1, 2, 2
    v_lshl_add_u32 v15, v15, 2, v14
    v_lshlrev_b32 v15, 7, v15
    v_bfe_u32 v14, v1, 3, 1
    v_lshl_add_u32 v15, v14, 6, v15
    v_bfe_u32 v14, v1, 4, 1
    v_lshl_add_u32 v15, v14, 5, v15
    v_and_b32 v14, 3, v1
    v_lshl_add_u32 v15, v14, 3, v15
    s_mul_i32 s8, s15, 22528
    s_add_u32 s8, s8, 90112
    v_add_u32 v3, s8, v15
    v_xor_b32 v4, 64, v3
    v_mov_b32 v13, s68
    v_mov_b32 v14, 0
    s_cmp_eq_u32 s74, 2
    s_cbranch_scc1 Lg133
    s_mov_b64 exec, 1
    s_waitcnt vmcnt(0)
    buffer_store_dword v13, v14, s[64:67], s78 offen sc1
    s_mov_b64 exec, -1
Lg133:
    s_lshl_b32 s8, s69, 3
    s_and_b32 s9, s70, 3
    s_lshl_b32 s9, s9, 1
    s_add_u32 s8, s8, s9
    s_add_u32 s76, s8, s14
    s_mul_i32 s77, s76, 90112
    s_mul_i32 s8, s15, 45056
    s_add_u32 s77, s77, s8
    s_add_u32 s77, s77, 8388608
    s_mov_b32 s5, 0x8000
Lp134:
    ds_read_b32 v11, v2 offset:0
    s_waitcnt lgkmcnt(0)
    v_readfirstlane_b32 s4, v11
    s_nop 0
    s_cmp_ge_u32 s4, 33
    s_cbranch_scc1 Lpe135
    s_sleep 1
    s_sub_u32 s5, s5, 1
    s_cmp_lg_u32 s5, 0
    s_cbranch_scc1 Lp134
Lpe135:
    ds_read_b64_tr_b16 v[16:17], v3 offset:0
    ds_read_b64_tr_b16 v[18:19], v3 offset:1024
    ds_read_b64_tr_b16 v[20:21], v4 offset:0
    ds_read_b64_tr_b16 v[22:23], v4 offset:1024
    ds_read_b64_tr_b16 v[24:25], v3 offset:2048
    ds_read_b64_tr_b16 v[26:27], v3 offset:3072
    ds_read_b64_tr_b16 v[28:29], v4 offset:2048
    ds_read_b64_tr_b16 v[30:31], v4 offset:3072
    ds_read_b64_tr_b16 v[32:33], v3 offset:4096
    ds_read_b64_tr_b16 v[34:35], v3 offset:5120
    ds_read_b64_tr_b16 v[36:37], v4 offset:4096
    ds_read_b64_tr_b16 v[38:39], v4 offset:5120
    ds_read_b64_tr_b16 v[40:41], v3 offset:6144
    ds_read_b64_tr_b16 v[42:43], v3 offset:7168
    ds_read_b64_tr_b16 v[44:45], v4 offset:6144
    ds_read_b64_tr_b16 v[46:47], v4 offset:7168
    ds_read_b64_tr_b16 v[112:113], v3 offset:8192
    ds_read_b64_tr_b16 v[114:115], v3 offset:9216
    ds_read_b64_tr_b16 v[116:117], v4 offset:8192
    ds_read_b64_tr_b16 v[118:119], v4 offset:9216
    ds_read_b64_tr_b16 v[120:121], v3 offset:10240
    ds_read_b64_tr_b16 v[122:123], v3 offset:11264
    ds_read_b64_tr_b16 v[124:125], v4 offset:10240
    ds_read_b64_tr_b16 v[126:127], v4 offset:11264
    ds_read_b64_tr_b16 v[128:129], v3 offset:12288
    ds_read_b64_tr_b16 v[130:131], v3 offset:13312
    ds_read_b64_tr_b16 v[132:133], v4 offset:12288
    ds_read_b64_tr_b16 v[134:135], v4 offset:13312
    ds_read_b64_tr_b16 v[136:137], v3 offset:14336
    ds_read_b64_tr_b16 v[138:139], v3 offset:15360
    ds_read_b64_tr_b16 v[140:141], v4 offset:14336
    ds_read_b64_tr_b16 v[142:143], v4 offset:15360
    ds_read_b64_tr_b16 v[144:145], v3 offset:16384
    ds_read_b64_tr_b16 v[146:147], v3 offset:17408
    ds_read_b64_tr_b16 v[148:149], v4 offset:16384
    ds_read_b64_tr_b16 v[150:151], v4 offset:17408
    ds_read_b64_tr_b16 v[152:153], v3 offset:18432
    ds_read_b64_tr_b16 v[154:155], v3 offset:19456
    ds_read_b64_tr_b16 v[156:157], v4 offset:18432
    ds_read_b64_tr_b16 v[158:159], v4 offset:19456
    ds_read_b64_tr_b16 v[160:161], v3 offset:20480
    ds_read_b64_tr_b16 v[162:163], v3 offset:21504
    ds_read_b64_tr_b16 v[164:165], v4 offset:20480
    ds_read_b64_tr_b16 v[166:167], v4 offset:21504
    v_mov_b32 v14, 10
    ds_write_b32 v10, v14 offset:16
    s_add_u32 s9, s15, 14
    v_min_u32 v13, s9, v1
    v_lshlrev_b32 v13, 7, v13
    s_lshr_b32 s8, s76, 1
    s_lshl_b32 s8, s8, 5
    s_mul_i32 s9, s15, 14
    s_add_u32 s8, s8, s9
    s_lshl_b32 s8, s8, 7
    s_add_u32 s8, s8, 393216
    s_mov_b64 exec, 0xffff
    s_mov_b32 s5, 0x4000
Lf136:
    buffer_load_dword v14, v13, s[64:67], s8 offen sc1
    s_waitcnt vmcnt(0)
    v_cmp_ne_u32 vcc, s68, v14
    s_cbranch_vccz Lfe137
    s_sleep 2
    s_sub_u32 s5, s5, 1
    s_cmp_lg_u32 s5, 0
    s_cbranch_scc1 Lf136
Lfe137:
    s_mov_b64 exec, -1
    s_add_u32 s8, s77, 0
    buffer_load_dwordx4 v[80:83], v12, s[64:67], s8 offen offset:0 sc1
    buffer_load_dwordx4 v[84:87], v12, s[64:67], s8 offen offset:1024 sc1
    buffer_load_dwordx4 v[88:91], v12, s[64:67], s8 offen offset:2048 sc1
    buffer_load_dwordx4 v[92:95], v12, s[64:67], s8 offen offset:3072 sc1
    s_add_u32 s8, s77, 4096
    buffer_load_dwordx4 v[96:99], v12, s[64:67], s8 offen offset:0 sc1
    buffer_load_dwordx4 v[100:103], v12, s[64:67], s8 offen offset:1024 sc1
    buffer_load_dwordx4 v[104:107], v12, s[64:67], s8 offen offset:2048 sc1
    buffer_load_dwordx4 v[108:111], v12, s[64:67], s8 offen offset:3072 sc1
    s_setprio 0
    s_waitcnt lgkmcnt(0)
    s_waitcnt vmcnt(7)
    v_mfma_f32_32x32x16_bf16 v[48:63], v[16:19], v[80:83], 0
    v_mfma_f32_32x32x16_bf16 v[64:79], v[20:23], v[80:83], 0
    s_add_u32 s8, s77, 8192
    buffer_load_dwordx4 v[80:83], v12, s[64:67], s8 offen offset:0 sc1
    s_waitcnt vmcnt(7)
    v_mfma_f32_32x32x16_bf16 v[48:63], v[24:27], v[84:87], v[48:63]
    v_mfma_f32_32x32x16_bf16 v[64:79], v[28:31], v[84:87], v[64:79]
    buffer_load_dwordx4 v[84:87], v12, s[64:67], s8 offen offset:1024 sc1
    s_waitcnt vmcnt(7)
    v_mfma_f32_32x32x16_bf16 v[48:63], v[32:35], v[88:91], v[48:63]
    v_mfma_f32_32x32x16_bf16 v[64:79], v[36:39], v[88:91], v[64:79]
    buffer_load_dwordx4 v[88:91], v12, s[64:67], s8 offen offset:2048 sc1
    s_waitcnt vmcnt(7)
    v_mfma_f32_32x32x16_bf16 v[48:63], v[40:43], v[92:95], v[48:63]
    v_mfma_f32_32x32x16_bf16 v[64:79], v[44:47], v[92:95], v[64:79]
    buffer_load_dwordx4 v[92:95], v12, s[64:67], s8 offen offset:3072 sc1
    s_waitcnt vmcnt(7)
    v_mfma_f32_32x32x16_bf16 v[48:63], v[112:115], v[96:99], v[48:63]
    ds_read_b32 v11, v2 offset:0
    v_mfma_f32_32x32x16_bf16 v[64:79], v[116:119], v[96:99], v[64:79]
    s_add_u32 s8, s77, 12288
    buffer_load_dwordx4 v[96:99], v12, s[64:67], s8 offen offset:0 sc1
    s_waitcnt vmcnt(7)
    v_mfma_f32_32x32x16_bf16 v[48:63], v[120:123], v[100:103], v[48:63]
    v_mfma_f32_32x32x16_bf16 v[64:79], v[124:127], v[100:103], v[64:79]
    buffer_load_dwordx4 v[100:103], v12, s[64:67], s8 offen offset:1024 sc1
    s_waitcnt vmcnt(7)
    v_mfma_f32_32x32x16_bf16 v[48:63], v[128:131], v[104:107], v[48:63]
    v_mfma_f32_32x32x16_bf16 v[64:79], v[132:135], v[104:107], v[64:79]
    buffer_load_dwordx4 v[104:107], v12, s[64:67], s8 offen offset:2048 sc1
    s_waitcnt vmcnt(7)
    v_mfma_f32_32x32x16_bf16 v[48:63], v[136:139], v[108:111], v[48:63]
    s_waitcnt lgkmcnt(0)
    v_readfirstlane_b32 s4, v11
    v_mfma_f32_32x32x16_bf16 v[64:79], v[140:143], v[108:111], v[64:79]
    s_cmp_lt_u32 s4, 34
    s_cbranch_scc1 Lgs138
Lgr139:
    buffer_load_dwordx4 v[108:111], v12, s[64:67], s8 offen offset:3072 sc1
    s_waitcnt vmcnt(7)
    v_mfma_f32_32x32x16_bf16 v[48:63], v[144:147], v[80:83], v[48:63]
    v_subrev_u32 v3, 90112, v3
    v_subrev_u32 v4, 90112, v4
    ds_read_b64_tr_b16 v[40:41], v3 offset:0
    ds_read_b64_tr_b16 v[42:43], v3 offset:1024
    v_mfma_f32_32x32x16_bf16 v[64:79], v[148:151], v[80:83], v[64:79]
    ds_read_b64_tr_b16 v[44:45], v4 offset:0
    ds_read_b64_tr_b16 v[46:47], v4 offset:1024
    s_add_u32 s8, s77, 16384
    buffer_load_dwordx4 v[80:83], v12, s[64:67], s8 offen offset:0 sc1
    s_waitcnt vmcnt(7)
    v_mfma_f32_32x32x16_bf16 v[48:63], v[152:155], v[84:87], v[48:63]
    ds_read_b64_tr_b16 v[16:17], v3 offset:2048
    ds_read_b64_tr_b16 v[18:19], v3 offset:3072
    v_mfma_f32_32x32x16_bf16 v[64:79], v[156:159], v[84:87], v[64:79]
    ds_read_b64_tr_b16 v[20:21], v4 offset:2048
    ds_read_b64_tr_b16 v[22:23], v4 offset:3072
    buffer_load_dwordx4 v[84:87], v12, s[64:67], s8 offen offset:1024 sc1
    s_waitcnt vmcnt(7)
    v_mfma_f32_32x32x16_bf16 v[48:63], v[160:163], v[88:91], v[48:63]
    ds_read_b64_tr_b16 v[24:25], v3 offset:4096
    ds_read_b64_tr_b16 v[26:27], v3 offset:5120
    v_mfma_f32_32x32x16_bf16 v[64:79], v[164:167], v[88:91], v[64:79]
    ds_read_b64_tr_b16 v[28:29], v4 offset:4096
    ds_read_b64_tr_b16 v[30:31], v4 offset:5120
    buffer_load_dwordx4 v[88:91], v12, s[64:67], s8 offen offset:2048 sc1
    s_waitcnt vmcnt(7)
    s_waitcnt lgkmcnt(10)
    v_mfma_f32_32x32x16_bf16 v[48:63], v[40:43], v[92:95], v[48:63]
    ds_read_b64_tr_b16 v[32:33], v3 offset:6144
    ds_read_b64_tr_b16 v[34:35], v3 offset:7168
    s_waitcnt lgkmcnt(10)
    v_mfma_f32_32x32x16_bf16 v[64:79], v[44:47], v[92:95], v[64:79]
    ds_read_b64_tr_b16 v[36:37], v4 offset:6144
    ds_read_b64_tr_b16 v[38:39], v4 offset:7168
    buffer_load_dwordx4 v[92:95], v12, s[64:67], s8 offen offset:3072 sc1
    s_waitcnt vmcnt(7)
    s_waitcnt lgkmcnt(10)
    v_mfma_f32_32x32x16_bf16 v[48:63], v[16:19], v[96:99], v[48:63]
    ds_read_b64_tr_b16 v[40:41], v3 offset:8192
    ds_read_b64_tr_b16 v[42:43], v3 offset:9216
    s_waitcnt lgkmcnt(10)
    v_mfma_f32_32x32x16_bf16 v[64:79], v[20:23], v[96:99], v[64:79]
    ds_read_b64_tr_b16 v[44:45], v4 offset:8192
    ds_read_b64_tr_b16 v[46:47], v4 offset:9216
    s_add_u32 s8, s77, 20480
    buffer_load_dwordx4 v[96:99], v12, s[64:67], s8 offen offset:0 sc1
    s_waitcnt vmcnt(7)
    s_waitcnt lgkmcnt(10)
    v_mfma_f32_32x32x16_bf16 v[48:63], v[24:27], v[100:103], v[48:63]
    ds_read_b64_tr_b16 v[16:17], v3 offset:10240
    ds_read_b64_tr_b16 v[18:19], v3 offset:11264
    s_waitcnt lgkmcnt(10)
    v_mfma_f32_32x32x16_bf16 v[64:79], v[28:31], v[100:103], v[64:79]
    ds_read_b64_tr_b16 v[20:21], v4 offset:10240
    ds_read_b64_tr_b16 v[22:23], v4 offset:11264
    buffer_load_dwordx4 v[100:103], v12, s[64:67], s8 offen offset:1024 sc1
    s_waitcnt vmcnt(7)
    s_waitcnt lgkmcnt(10)
    v_mfma_f32_32x32x16_bf16 v[48:63], v[32:35], v[104:107], v[48:63]
    ds_read_b64_tr_b16 v[24:25], v3 offset:12288
    ds_read_b64_tr_b16 v[26:27], v3 offset:13312
    s_waitcnt lgkmcnt(10)
    v_mfma_f32_32x32x16_bf16 v[64:79], v[36:39], v[104:107], v[64:79]
    ds_read_b64_tr_b16 v[28:29], v4 offset:12288
    ds_read_b64_tr_b16 v[30:31], v4 offset:13312
    buffer_load_dwordx4 v[104:107], v12, s[64:67], s8 offen offset:2048 sc1
    s_waitcnt vmcnt(7)
    s_waitcnt lgkmcnt(10)
    v_mfma_f32_32x32x16_bf16 v[48:63], v[40:43], v[108:111], v[48:63]
    ds_read_b32 v11, v2 offset:0
    ds_read_b64_tr_b16 v[32:33], v3 offset:14336
    ds_read_b64_tr_b16 v[34:35], v3 offset:15360
    s_waitcnt lgkmcnt(11)
    v_mfma_f32_32x32x16_bf16 v[64:79], v[44:47], v[108:111], v[64:79]
    ds_read_b64_tr_b16 v[36:37], v4 offset:14336
    ds_read_b64_tr_b16 v[38:39], v4 offset:15360
    buffer_load_dwordx4 v[108:111], v12, s[64:67], s8 offen offset:3072 sc1
    s_waitcnt vmcnt(7)
    s_waitcnt lgkmcnt(11)
    v_mfma_f32_32x32x16_bf16 v[48:63], v[16:19], v[80:83], v[48:63]
    ds_read_b64_tr_b16 v[40:41], v3 offset:16384
    ds_read_b64_tr_b16 v[42:43], v3 offset:17408
    s_waitcnt lgkmcnt(11)
    v_mfma_f32_32x32x16_bf16 v[64:79], v[20:23], v[80:83], v[64:79]
    ds_read_b64_tr_b16 v[44:45], v4 offset:16384
    ds_read_b64_tr_b16 v[46:47], v4 offset:17408
    s_add_u32 s8, s77, 24576
    buffer_load_dwordx4 v[80:83], v12, s[64:67], s8 offen offset:0 sc1
    s_waitcnt vmcnt(7)
    s_waitcnt lgkmcnt(11)
    v_mfma_f32_32x32x16_bf16 v[48:63], v[24:27], v[84:87], v[48:63]
    ds_read_b64_tr_b16 v[16:17], v3 offset:18432
    ds_read_b64_tr_b16 v[18:19], v3 offset:19456
    s_waitcnt lgkmcnt(11)
    v_mfma_f32_32x32x16_bf16 v[64:79], v[28:31], v[84:87], v[64:79]
    ds_read_b64_tr_b16 v[20:21], v4 offset:18432
    ds_read_b64_tr_b16 v[22:23], v4 offset:19456
    buffer_load_dwordx4 v[84:87], v12, s[64:67], s8 offen offset:1024 sc1
    s_waitcnt vmcnt(7)
    s_waitcnt lgkmcnt(10)
    v_mfma_f32_32x32x16_bf16 v[48:63], v[32:35], v[88:91], v[48:63]
    v_readfirstlane_b32 s4, v11
    ds_read_b64_tr_b16 v[24:25], v3 offset:20480
    ds_read_b64_tr_b16 v[26:27], v3 offset:21504
    s_waitcnt lgkmcnt(10)
    v_mfma_f32_32x32x16_bf16 v[64:79], v[36:39], v[88:91], v[64:79]
    s_cmp_lt_u32 s4, 35
    s_cbranch_scc1 Lgs142
Lgr143:
    ds_read_b64_tr_b16 v[28:29], v4 offset:20480
    ds_read_b64_tr_b16 v[30:31], v4 offset:21504
    buffer_load_dwordx4 v[88:91], v12, s[64:67], s8 offen offset:2048 sc1
    v_mov_b32 v14, 11
    ds_write_b32 v10, v14 offset:16
    s_waitcnt vmcnt(7)
    s_waitcnt lgkmcnt(11)
    v_mfma_f32_32x32x16_bf16 v[48:63], v[40:43], v[92:95], v[48:63]
    v_add_u32 v3, 45056, v3
    v_add_u32 v4, 45056, v4
    ds_read_b64_tr_b16 v[32:33], v3 offset:0
    ds_read_b64_tr_b16 v[34:35], v3 offset:1024
    s_waitcnt lgkmcnt(11)
    v_mfma_f32_32x32x16_bf16 v[64:79], v[44:47], v[92:95], v[64:79]
    ds_read_b64_tr_b16 v[36:37], v4 offset:0
    ds_read_b64_tr_b16 v[38:39], v4 offset:1024
    buffer_load_dwordx4 v[92:95], v12, s[64:67], s8 offen offset:3072 sc1
    s_waitcnt vmcnt(7)
    s_waitcnt lgkmcnt(11)
    v_mfma_f32_32x32x16_bf16 v[48:63], v[16:19], v[96:99], v[48:63]
    ds_read_b64_tr_b16 v[40:41], v3 offset:2048
    ds_read_b64_tr_b16 v[42:43], v3 offset:3072
    s_waitcnt lgkmcnt(11)
    v_mfma_f32_32x32x16_bf16 v[64:79], v[20:23], v[96:99], v[64:79]
    ds_read_b64_tr_b16 v[44:45], v4 offset:2048
    ds_read_b64_tr_b16 v[46:47], v4 offset:3072
    s_add_u32 s8, s77, 28672
    buffer_load_dwordx4 v[96:99], v12, s[64:67], s8 offen offset:0 sc1
    s_waitcnt vmcnt(7)
    s_waitcnt lgkmcnt(11)
    v_mfma_f32_32x32x16_bf16 v[48:63], v[24:27], v[100:103], v[48:63]
    ds_read_b64_tr_b16 v[16:17], v3 offset:4096
    ds_read_b64_tr_b16 v[18:19], v3 offset:5120
    s_waitcnt lgkmcnt(11)
    v_mfma_f32_32x32x16_bf16 v[64:79], v[28:31], v[100:103], v[64:79]
    ds_read_b64_tr_b16 v[20:21], v4 offset:4096
    ds_read_b64_tr_b16 v[22:23], v4 offset:5120
    buffer_load_dwordx4 v[100:103], v12, s[64:67], s8 offen offset:1024 sc1
    s_waitcnt vmcnt(7)
    s_waitcnt lgkmcnt(10)
    v_mfma_f32_32x32x16_bf16 v[48:63], v[32:35], v[104:107], v[48:63]
    ds_read_b64_tr_b16 v[24:25], v3 offset:6144
    ds_read_b64_tr_b16 v[26:27], v3 offset:7168
    s_waitcnt lgkmcnt(10)
    v_mfma_f32_32x32x16_bf16 v[64:79], v[36:39], v[104:107], v[64:79]
    ds_read_b64_tr_b16 v[28:29], v4 offset:6144
    ds_read_b64_tr_b16 v[30:31], v4 offset:7168
    buffer_load_dwordx4 v[104:107], v12, s[64:67], s8 offen offset:2048 sc1
    s_waitcnt vmcnt(7)
    s_waitcnt lgkmcnt(10)
    v_mfma_f32_32x32x16_bf16 v[48:63], v[40:43], v[108:111], v[48:63]
    ds_read_b64_tr_b16 v[32:33], v3 offset:8192
    ds_read_b64_tr_b16 v[34:35], v3 offset:9216
    s_waitcnt lgkmcnt(10)
    v_mfma_f32_32x32x16_bf16 v[64:79], v[44:47], v[108:111], v[64:79]
    ds_read_b64_tr_b16 v[36:37], v4 offset:8192
    ds_read_b64_tr_b16 v[38:39], v4 offset:9216
    buffer_load_dwordx4 v[108:111], v12, s[64:67], s8 offen offset:3072 sc1
    s_waitcnt vmcnt(7)
    s_waitcnt lgkmcnt(10)
    v_mfma_f32_32x32x16_bf16 v[48:63], v[16:19], v[80:83], v[48:63]
    ds_read_b64_tr_b16 v[40:41], v3 offset:10240
    ds_read_b64_tr_b16 v[42:43], v3 offset:11264
    s_waitcnt lgkmcnt(10)
    v_mfma_f32_32x32x16_bf16 v[64:79], v[20:23], v[80:83], v[64:79]
    ds_read_b64_tr_b16 v[44:45], v4 offset:10240
    ds_read_b64_tr_b16 v[46:47], v4 offset:11264
    s_add_u32 s8, s77, 32768
    buffer_load_dwordx4 v[80:83], v12, s[64:67], s8 offen offset:0 sc1
    s_waitcnt vmcnt(7)
    s_waitcnt lgkmcnt(10)
    v_mfma_f32_32x32x16_bf16 v[48:63], v[24:27], v[84:87], v[48:63]
    ds_read_b64_tr_b16 v[16:17], v3 offset:12288
    ds_read_b64_tr_b16 v[18:19], v3 offset:13312
    s_waitcnt lgkmcnt(10)
    v_mfma_f32_32x32x16_bf16 v[64:79], v[28:31], v[84:87], v[64:79]
    ds_read_b64_tr_b16 v[20:21], v4 offset:12288
    ds_read_b64_tr_b16 v[22:23], v4 offset:13312
    buffer_load_dwordx4 v[84:87], v12, s[64:67], s8 offen offset:1024 sc1
    s_waitcnt vmcnt(7)
    s_waitcnt lgkmcnt(10)
    v_mfma_f32_32x32x16_bf16 v[48:63], v[32:35], v[88:91], v[48:63]
    ds_read_b32 v11, v2 offset:0
    ds_read_b64_tr_b16 v[24:25], v3 offset:14336
    ds_read_b64_tr_b16 v[26:27], v3 offset:15360
    s_waitcnt lgkmcnt(11)
    v_mfma_f32_32x32x16_bf16 v[64:79], v[36:39], v[88:91], v[64:79]
    ds_read_b64_tr_b16 v[28:29], v4 offset:14336
    ds_read_b64_tr_b16 v[30:31], v4 offset:15360
    buffer_load_dwordx4 v[88:91], v12, s[64:67], s8 offen offset:2048 sc1
    s_waitcnt vmcnt(7)
    s_waitcnt lgkmcnt(11)
    v_mfma_f32_32x32x16_bf16 v[48:63], v[40:43], v[92:95], v[48:63]
    ds_read_b64_tr_b16 v[32:33], v3 offset:16384
    ds_read_b64_tr_b16 v[34:35], v3 offset:17408
    s_waitcnt lgkmcnt(11)
    v_mfma_f32_32x32x16_bf16 v[64:79], v[44:47], v[92:95], v[64:79]
    ds_read_b64_tr_b16 v[36:37], v4 offset:16384
    ds_read_b64_tr_b16 v[38:39], v4 offset:17408
    buffer_load_dwordx4 v[92:95], v12, s[64:67], s8 offen offset:3072 sc1
    s_waitcnt vmcnt(7)
    s_waitcnt lgkmcnt(11)
    v_mfma_f32_32x32x16_bf16 v[48:63], v[16:19], v[96:99], v[48:63]
    ds_read_b64_tr_b16 v[40:41], v3 offset:18432
    ds_read_b64_tr_b16 v[42:43], v3 offset:19456
    s_waitcnt lgkmcnt(11)
    v_mfma_f32_32x32x16_bf16 v[64:79], v[20:23], v[96:99], v[64:79]
    ds_read_b64_tr_b16 v[44:45], v4 offset:18432
    ds_read_b64_tr_b16 v[46:47], v4 offset:19456
    s_add_u32 s8, s77, 36864
    buffer_load_dwordx4 v[96:99], v12, s[64:67], s8 offen offset:0 sc1
    s_waitcnt vmcnt(7)
    s_waitcnt lgkmcnt(10)
    v_mfma_f32_32x32x16_bf16 v[48:63], v[24:27], v[100:103], v[48:63]
    v_readfirstlane_b32 s4, v11
    ds_read_b64_tr_b16 v[16:17], v3 offset:20480
    ds_read_b64_tr_b16 v[18:19], v3 offset:21504
    s_waitcnt lgkmcnt(10)
    v_mfma_f32_32x32x16_bf16 v[64:79], v[28:31], v[100:103], v[64:79]
    s_cmp_lt_u32 s4, 36
    s_cbranch_scc1 Lgs146
Lgr147:
    ds_read_b64_tr_b16 v[20:21], v4 offset:20480
    ds_read_b64_tr_b16 v[22:23], v4 offset:21504
    buffer_load_dwordx4 v[100:103], v12, s[64:67], s8 offen offset:1024 sc1
    s_waitcnt vmcnt(7)
    s_waitcnt lgkmcnt(10)
    v_mfma_f32_32x32x16_bf16 v[48:63], v[32:35], v[104:107], v[48:63]
    v_add_u32 v3, 45056, v3
    v_add_u32 v4, 45056, v4
    ds_read_b64_tr_b16 v[24:25], v3 offset:0
    ds_read_b64_tr_b16 v[26:27], v3 offset:1024
    s_waitcnt lgkmcnt(10)
    v_mfma_f32_32x32x16_bf16 v[64:79], v[36:39], v[104:107], v[64:79]
    ds_read_b64_tr_b16 v[28:29], v4 offset:0
    ds_read_b64_tr_b16 v[30:31], v4 offset:1024
    buffer_load_dwordx4 v[104:107], v12, s[64:67], s8 offen offset:2048 sc1
    s_waitcnt vmcnt(7)
    s_waitcnt lgkmcnt(10)
    v_mfma_f32_32x32x16_bf16 v[48:63], v[40:43], v[108:111], v[48:63]
    ds_read_b64_tr_b16 v[32:33], v3 offset:2048
    ds_read_b64_tr_b16 v[34:35], v3 offset:3072
    s_waitcnt lgkmcnt(10)
    v_mfma_f32_32x32x16_bf16 v[64:79], v[44:47], v[108:111], v[64:79]
    ds_read_b64_tr_b16 v[36:37], v4 offset:2048
    ds_read_b64_tr_b16 v[38:39], v4 offset:3072
    buffer_load_dwordx4 v[108:111], v12, s[64:67], s8 offen offset:3072 sc1
    s_waitcnt vmcnt(7)
    s_waitcnt lgkmcnt(10)
    v_mfma_f32_32x32x16_bf16 v[48:63], v[16:19], v[80:83], v[48:63]
    ds_read_b64_tr_b16 v[40:41], v3 offset:4096
    ds_read_b64_tr_b16 v[42:43], v3 offset:5120
    s_waitcnt lgkmcnt(10)
    v_mfma_f32_32x32x16_bf16 v[64:79], v[20:23], v[80:83], v[64:79]
    ds_read_b64_tr_b16 v[44:45], v4 offset:4096
    ds_read_b64_tr_b16 v[46:47], v4 offset:5120
    s_add_u32 s8, s77, 40960
    buffer_load_dwordx4 v[80:83], v12, s[64:67], s8 offen offset:0 sc1
    s_waitcnt vmcnt(7)
    s_waitcnt lgkmcnt(10)
    v_mfma_f32_32x32x16_bf16 v[48:63], v[24:27], v[84:87], v[48:63]
    ds_read_b64_tr_b16 v[16:17], v3 offset:6144
    ds_read_b64_tr_b16 v[18:19], v3 offset:7168
    s_waitcnt lgkmcnt(10)
    v_mfma_f32_32x32x16_bf16 v[64:79], v[28:31], v[84:87], v[64:79]
    ds_read_b64_tr_b16 v[20:21], v4 offset:6144
    ds_read_b64_tr_b16 v[22:23], v4 offset:7168
    buffer_load_dwordx4 v[84:87], v12, s[64:67], s8 offen offset:1024 sc1
    s_waitcnt vmcnt(7)
    s_waitcnt lgkmcnt(10)
    v_mfma_f32_32x32x16_bf16 v[48:63], v[32:35], v[88:91], v[48:63]
    ds_read_b64_tr_b16 v[24:25], v3 offset:8192
    ds_read_b64_tr_b16 v[26:27], v3 offset:9216
    s_waitcnt lgkmcnt(10)
    v_mfma_f32_32x32x16_bf16 v[64:79], v[36:39], v[88:91], v[64:79]
    ds_read_b64_tr_b16 v[28:29], v4 offset:8192
    ds_read_b64_tr_b16 v[30:31], v4 offset:9216
    buffer_load_dwordx4 v[88:91], v12, s[64:67], s8 offen offset:2048 sc1
    s_waitcnt vmcnt(7)
    s_waitcnt lgkmcnt(10)
    v_mfma_f32_32x32x16_bf16 v[48:63], v[40:43], v[92:95], v[48:63]
    ds_read_b64_tr_b16 v[32:33], v3 offset:10240
    ds_read_b64_tr_b16 v[34:35], v3 offset:11264
    s_waitcnt lgkmcnt(10)
    v_mfma_f32_32x32x16_bf16 v[64:79], v[44:47], v[92:95], v[64:79]
    ds_read_b64_tr_b16 v[36:37], v4 offset:10240
    ds_read_b64_tr_b16 v[38:39], v4 offset:11264
    buffer_load_dwordx4 v[92:95], v12, s[64:67], s8 offen offset:3072 sc1
    s_waitcnt vmcnt(7)
    s_waitcnt lgkmcnt(10)
    v_mfma_f32_32x32x16_bf16 v[48:63], v[16:19], v[96:99], v[48:63]
    ds_read_b64_tr_b16 v[40:41], v3 offset:12288
    ds_read_b64_tr_b16 v[42:43], v3 offset:13312
    s_waitcnt lgkmcnt(10)
    v_mfma_f32_32x32x16_bf16 v[64:79], v[20:23], v[96:99], v[64:79]
    ds_read_b64_tr_b16 v[44:45], v4 offset:12288
    ds_read_b64_tr_b16 v[46:47], v4 offset:13312
    s_waitcnt vmcnt(6)
    s_waitcnt lgkmcnt(10)
    v_mfma_f32_32x32x16_bf16 v[48:63], v[24:27], v[100:103], v[48:63]
    ds_read_b64_tr_b16 v[16:17], v3 offset:14336
    ds_read_b64_tr_b16 v[18:19], v3 offset:15360
    s_waitcnt lgkmcnt(10)
    v_mfma_f32_32x32x16_bf16 v[64:79], v[28:31], v[100:103], v[64:79]
    ds_read_b64_tr_b16 v[20:21], v4 offset:14336
    ds_read_b64_tr_b16 v[22:23], v4 offset:15360
    s_waitcnt vmcnt(5)
    s_waitcnt lgkmcnt(10)
    v_mfma_f32_32x32x16_bf16 v[48:63], v[32:35], v[104:107], v[48:63]
    ds_read_b64_tr_b16 v[24:25], v3 offset:16384
    ds_read_b64_tr_b16 v[26:27], v3 offset:17408
    s_waitcnt lgkmcnt(10)
    v_mfma_f32_32x32x16_bf16 v[64:79], v[36:39], v[104:107], v[64:79]
    ds_read_b64_tr_b16 v[28:29], v4 offset:16384
    ds_read_b64_tr_b16 v[30:31], v4 offset:17408
    s_waitcnt vmcnt(4)
    s_waitcnt lgkmcnt(10)
    v_mfma_f32_32x32x16_bf16 v[48:63], v[40:43], v[108:111], v[48:63]
    ds_read_b64_tr_b16 v[32:33], v3 offset:18432
    ds_read_b64_tr_b16 v[34:35], v3 offset:19456
    s_waitcnt lgkmcnt(10)
    v_mfma_f32_32x32x16_bf16 v[64:79], v[44:47], v[108:111], v[64:79]
    ds_read_b64_tr_b16 v[36:37], v4 offset:18432
    ds_read_b64_tr_b16 v[38:39], v4 offset:19456
    s_waitcnt vmcnt(3)
    s_waitcnt lgkmcnt(10)
    v_mfma_f32_32x32x16_bf16 v[48:63], v[16:19], v[80:83], v[48:63]
    ds_read_b64_tr_b16 v[40:41], v3 offset:20480
    ds_read_b64_tr_b16 v[42:43], v3 offset:21504
    s_waitcnt lgkmcnt(10)
    v_mfma_f32_32x32x16_bf16 v[64:79], v[20:23], v[80:83], v[64:79]
    ds_read_b64_tr_b16 v[44:45], v4 offset:20480
    ds_read_b64_tr_b16 v[46:47], v4 offset:21504
    s_waitcnt vmcnt(2)
    s_waitcnt lgkmcnt(10)
    v_mfma_f32_32x32x16_bf16 v[48:63], v[24:27], v[84:87], v[48:63]
    ds_read_b32 v11, v2 offset:92
    s_waitcnt lgkmcnt(9)
    v_mfma_f32_32x32x16_bf16 v[64:79], v[28:31], v[84:87], v[64:79]
    v_and_b32 v3, 31, v1
    v_bfe_u32 v13, v1, 1, 3
    s_lshl_b32 s8, s15, 2
    v_xor_b32 v13, s8, v13
    v_lshlrev_b32 v13, 4, v13
    s_waitcnt vmcnt(1)
    s_waitcnt lgkmcnt(7)
    v_mfma_f32_32x32x16_bf16 v[48:63], v[32:35], v[88:91], v[48:63]
    v_lshl_add_u32 v13, v3, 7, v13
    v_lshrrev_b32 v4, 5, v1
    v_lshl_add_u32 v13, v4, 3, v13
    s_lshl_b32 s8, s14, 12
    s_add_u32 s8, s8, 143360
    v_add_u32 v6, s8, v13
    s_waitcnt lgkmcnt(5)
    v_mfma_f32_32x32x16_bf16 v[64:79], v[36:39], v[88:91], v[64:79]
    v_xor_b32 v7, 16, v6
    v_xor_b32 v8, 32, v6
    v_xor_b32 v9, 48, v6
    s_lshl_b32 s8, s14, 6
    v_xor_b32 v5, s8, v15
    s_lshl_b32 s8, s15, 12
    s_add_u32 s8, s8, 135168
    v_add_u32 v5, s8, v5
    s_waitcnt vmcnt(0)
    s_waitcnt lgkmcnt(3)
    v_mfma_f32_32x32x16_bf16 v[48:63], v[40:43], v[92:95], v[48:63]
    s_waitcnt lgkmcnt(0)
    v_readfirstlane_b32 s4, v11
    s_lshl_b32 s12, s13, 12
    v_add_u32 v14, s12, v12
    v_xor_b32 v10, 0x2000, v14
    v_mfma_f32_32x32x16_bf16 v[64:79], v[44:47], v[92:95], v[64:79]
    s_cmp_lt_u32 s4, 1
    s_cbranch_scc1 Lgs150
Lgr151:
    ds_read_b64 v[128:129], v6
    ds_read_b64 v[130:131], v7
    ds_read_b64 v[132:133], v8
    ds_read_b64 v[134:135], v9
    ds_read_b64_tr_b16 v[136:137], v5 offset:0
    ds_read_b64_tr_b16 v[138:139], v5 offset:1024
    ds_read_b64_tr_b16 v[140:141], v5 offset:2048
    ds_read_b64_tr_b16 v[142:143], v5 offset:3072
    s_cmp_eq_u32 s15, 0
    s_cbranch_scc1 Lg154
    ds_write_b128 v14, v[48:51] offset:0
    ds_write_b128 v14, v[52:55] offset:1024
    ds_write_b128 v14, v[56:59] offset:2048
    ds_write_b128 v14, v[60:63] offset:3072
    v_pk_mov_b32 v[48:49], v[64:65], v[64:65] op_sel:[0,1]
    v_pk_mov_b32 v[50:51], v[66:67], v[66:67] op_sel:[0,1]
    v_pk_mov_b32 v[52:53], v[68:69], v[68:69] op_sel:[0,1]
    v_pk_mov_b32 v[54:55], v[70:71], v[70:71] op_sel:[0,1]
    v_pk_mov_b32 v[56:57], v[72:73], v[72:73] op_sel:[0,1]
    v_pk_mov_b32 v[58:59], v[74:75], v[74:75] op_sel:[0,1]
    v_pk_mov_b32 v[60:61], v[76:77], v[76:77] op_sel:[0,1]
    v_pk_mov_b32 v[62:63], v[78:79], v[78:79] op_sel:[0,1]
    s_branch Lg155
Lg154:
    s_nop 3
    ds_write_b128 v14, v[64:67] offset:0
    ds_write_b128 v14, v[68:71] offset:1024
    ds_write_b128 v14, v[72:75] offset:2048
    ds_write_b128 v14, v[76:79] offset:3072
Lg155:
    s_waitcnt lgkmcnt(0)
    s_barrier
    ds_read_b128 v[64:67], v10 offset:0
    ds_read_b128 v[68:71], v10 offset:1024
    ds_read_b128 v[72:75], v10 offset:2048
    ds_read_b128 v[76:79], v10 offset:3072
    v_lshlrev_b32 v112, 16, v128
    v_lshlrev_b32 v96, 16, v136
    v_and_b32 v113, 0xffff0000, v128
    v_and_b32 v97, 0xffff0000, v136
    v_lshlrev_b32 v114, 16, v129
    v_lshlrev_b32 v98, 16, v137
    v_and_b32 v115, 0xffff0000, v129
    v_and_b32 v99, 0xffff0000, v137
    v_lshlrev_b32 v116, 16, v130
    v_lshlrev_b32 v100, 16, v138
    v_and_b32 v117, 0xffff0000, v130
    v_and_b32 v101, 0xffff0000, v138
    v_lshlrev_b32 v118, 16, v131
    v_lshlrev_b32 v102, 16, v139
    v_and_b32 v119, 0xffff0000, v131
    v_and_b32 v103, 0xffff0000, v139
    v_lshlrev_b32 v120, 16, v132
    v_lshlrev_b32 v104, 16, v140
    v_and_b32 v121, 0xffff0000, v132
    v_and_b32 v105, 0xffff0000, v140
    v_lshlrev_b32 v122, 16, v133
    v_lshlrev_b32 v106, 16, v141
    v_and_b32 v123, 0xffff0000, v133
    v_and_b32 v107, 0xffff0000, v141
    v_lshlrev_b32 v124, 16, v134
    v_lshlrev_b32 v108, 16, v142
    v_and_b32 v125, 0xffff0000, v134
    v_and_b32 v109, 0xffff0000, v142
    v_lshlrev_b32 v126, 16, v135
    v_lshlrev_b32 v110, 16, v143
    v_and_b32 v127, 0xffff0000, v135
    v_and_b32 v111, 0xffff0000, v143
    s_lshl_b32 s12, s13, 11
    s_add_u32 s12, s12, 16384
    v_lshlrev_b32 v3, 6, v3
    v_lshl_add_u32 v3, v4, 3, v3
    v_add_u32 v3, s12, v3
    v_add_u32 v4, s12, v12
    v_lshrrev_b32 v13, 2, v1
    v_and_b32 v14, 3, v1
    v_lshlrev_b32 v14, 4, v14
    v_lshl_add_u32 v6, v13, 10, v14
    s_lshr_b32 s9, s70, 2
    s_lshl_b32 s9, s9, 1
    s_add_u32 s9, s9, s15
    s_lshl_b32 s10, s76, 15
    s_lshl_b32 s11, s9, 6
    s_add_u32 s10, s10, s11
    s_add_u32 s11, s10, 16384
    v_mov_b32 v16, 0xbfb8aa3b
    v_mov_b32 v18, 1.0
    s_waitcnt lgkmcnt(0)
    v_pk_add_f32 v[48:49], v[48:49], v[64:65]
    v_pk_add_f32 v[50:51], v[50:51], v[66:67]
    v_pk_add_f32 v[52:53], v[52:53], v[68:69]
    v_pk_add_f32 v[54:55], v[54:55], v[70:71]
    v_pk_add_f32 v[56:57], v[56:57], v[72:73]
    v_pk_add_f32 v[58:59], v[58:59], v[74:75]
    v_pk_add_f32 v[60:61], v[60:61], v[76:77]
    v_pk_add_f32 v[62:63], v[62:63], v[78:79]
    v_pk_mul_f32 v[64:65], v[48:49], v[16:17] op_sel_hi:[1,0]
    v_pk_mul_f32 v[66:67], v[50:51], v[16:17] op_sel_hi:[1,0]
    v_pk_mul_f32 v[68:69], v[52:53], v[16:17] op_sel_hi:[1,0]
    v_pk_mul_f32 v[70:71], v[54:55], v[16:17] op_sel_hi:[1,0]
    v_pk_mul_f32 v[72:73], v[56:57], v[16:17] op_sel_hi:[1,0]
    v_pk_mul_f32 v[74:75], v[58:59], v[16:17] op_sel_hi:[1,0]
    v_pk_mul_f32 v[76:77], v[60:61], v[16:17] op_sel_hi:[1,0]
    v_pk_mul_f32 v[78:79], v[62:63], v[16:17] op_sel_hi:[1,0]
    v_exp_f32 v64, v64
    v_exp_f32 v65, v65
    v_exp_f32 v66, v66
    v_exp_f32 v67, v67
    v_exp_f32 v68, v68
    v_exp_f32 v69, v69
    v_exp_f32 v70, v70
    v_exp_f32 v71, v71
    v_exp_f32 v72, v72
    v_exp_f32 v73, v73
    v_exp_f32 v74, v74
    v_exp_f32 v75, v75
    v_exp_f32 v76, v76
    v_exp_f32 v77, v77
    v_exp_f32 v78, v78
    v_exp_f32 v79, v79
    v_pk_add_f32 v[64:65], v[64:65], v[18:19] op_sel_hi:[1,0]
    v_pk_add_f32 v[66:67], v[66:67], v[18:19] op_sel_hi:[1,0]
    v_pk_add_f32 v[68:69], v[68:69], v[18:19] op_sel_hi:[1,0]
    v_pk_add_f32 v[70:71], v[70:71], v[18:19] op_sel_hi:[1,0]
    v_pk_add_f32 v[72:73], v[72:73], v[18:19] op_sel_hi:[1,0]
    v_pk_add_f32 v[74:75], v[74:75], v[18:19] op_sel_hi:[1,0]
    v_pk_add_f32 v[76:77], v[76:77], v[18:19] op_sel_hi:[1,0]
    v_pk_add_f32 v[78:79], v[78:79], v[18:19] op_sel_hi:[1,0]
    v_pk_mul_f32 v[48:49], v[48:49], v[96:97]
    v_pk_mul_f32 v[50:51], v[50:51], v[98:99]
    v_pk_mul_f32 v[52:53], v[52:53], v[100:101]
    v_pk_mul_f32 v[54:55], v[54:55], v[102:103]
    v_pk_mul_f32 v[56:57], v[56:57], v[104:105]
    v_pk_mul_f32 v[58:59], v[58:59], v[106:107]
    v_pk_mul_f32 v[60:61], v[60:61], v[108:109]
    v_pk_mul_f32 v[62:63], v[62:63], v[110:111]
    v_rcp_f32 v64, v64
    v_rcp_f32 v65, v65
    v_rcp_f32 v66, v66
    v_rcp_f32 v67, v67
    v_rcp_f32 v68, v68
    v_rcp_f32 v69, v69
    v_rcp_f32 v70, v70
    v_rcp_f32 v71, v71
    v_rcp_f32 v72, v72
    v_rcp_f32 v73, v73
    v_rcp_f32 v74, v74
    v_rcp_f32 v75, v75
    v_rcp_f32 v76, v76
    v_rcp_f32 v77, v77
    v_rcp_f32 v78, v78
    v_rcp_f32 v79, v79
    v_pk_fma_f32 v[64:65], v[48:49], v[64:65], v[112:113]
    v_pk_fma_f32 v[66:67], v[50:51], v[66:67], v[114:115]
    v_pk_fma_f32 v[68:69], v[52:53], v[68:69], v[116:117]
    v_pk_fma_f32 v[70:71], v[54:55], v[70:71], v[118:119]
    v_pk_fma_f32 v[72:73], v[56:57], v[72:73], v[120:121]
    v_pk_fma_f32 v[74:75], v[58:59], v[74:75], v[122:123]
    v_pk_fma_f32 v[76:77], v[60:61], v[76:77], v[124:125]
    v_pk_fma_f32 v[78:79], v[62:63], v[78:79], v[126:127]
    v_cvt_pk_bf16_f32 v48, v64, v65
    v_cvt_pk_bf16_f32 v49, v66, v67
    v_cvt_pk_bf16_f32 v50, v68, v69
    v_cvt_pk_bf16_f32 v51, v70, v71
    v_cvt_pk_bf16_f32 v52, v72, v73
    v_cvt_pk_bf16_f32 v53, v74, v75
    v_cvt_pk_bf16_f32 v54, v76, v77
    v_cvt_pk_bf16_f32 v55, v78, v79
    ds_write_b64 v3, v[48:49] offset:0
    ds_write_b64 v3, v[50:51] offset:16
    ds_write_b64 v3, v[52:53] offset:32
    ds_write_b64 v3, v[54:55] offset:48
    ds_read_b128 v[56:59], v4
    ds_read_b128 v[60:63], v4 offset:1024
    s_waitcnt lgkmcnt(1)
    buffer_store_dwordx4 v[56:59], v6, s[60:63], s10 offen
    s_waitcnt lgkmcnt(0)
    buffer_store_dwordx4 v[60:63], v6, s[60:63], s11 offen
    s_lshl_b32 s8, s2, 4
    s_add_u32 s8, s8, s13
    s_cmp_lg_u32 s8, 0
    s_cbranch_scc1 Lg156
    v_mov_b32 v13, s68
    v_mov_b32 v14, 0
    s_mov_b64 exec, 1
    buffer_store_dword v13, v14, s[64:67], 0 offen
    s_mov_b64 exec, -1
Lg156:
    s_endpgm
L_Gskip:
    s_xor_b32 s8, s14, 1
    v_mov_b32 v14, s8
    s_mov_b64 exec, 1
    ds_add_u32 v2, v14 offset:84
    s_mov_b64 exec, -1
    s_cmp_eq_u32 s74, 2
    s_cbranch_scc1 L_Gepi
    v_mov_b32 v72, 0
    v_mov_b32 v73, 0
    v_mov_b32 v74, 0
    v_mov_b32 v75, 0
    s_sub_u32 s76, s76, 1024
    s_sub_u32 s77, s77, 1024
    buffer_store_dwordx4 v[72:75], v12, s[64:67], s76 offen offset:0 sc1
    buffer_store_dwordx4 v[72:75], v12, s[64:67], s76 offen offset:1024 sc1
    buffer_store_dwordx4 v[72:75], v12, s[64:67], s77 offen offset:0 sc1
    buffer_store_dwordx4 v[72:75], v12, s[64:67], s77 offen offset:1024 sc1
    s_branch L_Gepi
Lgs68:
    s_mov_b32 s5, 0x8000
Lp70:
    ds_read_b32 v11, v2 offset:0
    s_waitcnt lgkmcnt(0)
    v_readfirstlane_b32 s4, v11
    s_nop 0
    s_cmp_ge_u32 s4, 4
    s_cbranch_scc1 Lpe71
    s_sub_u32 s5, s5, 1
    s_cmp_lg_u32 s5, 0
    s_cbranch_scc1 Lp70
Lpe71:
    s_branch Lgr69
Lgs72:
    s_mov_b32 s5, 0x8000
Lp74:
    ds_read_b32 v11, v2 offset:0
    s_waitcnt lgkmcnt(0)
    v_readfirstlane_b32 s4, v11
    s_nop 0
    s_cmp_ge_u32 s4, 6
    s_cbranch_scc1 Lpe75
    s_sub_u32 s5, s5, 1
    s_cmp_lg_u32 s5, 0
    s_cbranch_scc1 Lp74
Lpe75:
    s_branch Lgr73
Lgs76:
    s_mov_b32 s5, 0x8000
Lp78:
    ds_read_b32 v11, v2 offset:0
    s_waitcnt lgkmcnt(0)
    v_readfirstlane_b32 s4, v11
    s_nop 0
    s_cmp_ge_u32 s4, 8
    s_cbranch_scc1 Lpe79
    s_sub_u32 s5, s5, 1
    s_cmp_lg_u32 s5, 0
    s_cbranch_scc1 Lp78
Lpe79:
    s_branch Lgr77
Lgs80:
    s_mov_b32 s5, 0x8000
Lp82:
    ds_read_b32 v11, v2 offset:0
    s_waitcnt lgkmcnt(0)
    v_readfirstlane_b32 s4, v11
    s_nop 0
    s_cmp_ge_u32 s4, 10
    s_cbranch_scc1 Lpe83
    s_sub_u32 s5, s5, 1
    s_cmp_lg_u32 s5, 0
    s_cbranch_scc1 Lp82
Lpe83:
    s_branch Lgr81
Lgs84:
    s_mov_b32 s5, 0x8000
Lp86:
    ds_read_b32 v11, v2 offset:0
    s_waitcnt lgkmcnt(0)
    v_readfirstlane_b32 s4, v11
    s_nop 0
    s_cmp_ge_u32 s4, 12
    s_cbranch_scc1 Lpe87
    s_sub_u32 s5, s5, 1
    s_cmp_lg_u32 s5, 0
    s_cbranch_scc1 Lp86
Lpe87:
    s_branch Lgr85
Lgs89:
    s_mov_b32 s5, 0x8000
Lp91:
    ds_read_b32 v11, v2 offset:0
    s_waitcnt lgkmcnt(0)
    v_readfirstlane_b32 s4, v11
    s_nop 0
    s_cmp_ge_u32 s4, 14
    s_cbranch_scc1 Lpe92
    s_sub_u32 s5, s5, 1
    s_cmp_lg_u32 s5, 0
    s_cbranch_scc1 Lp91
Lpe92:
    s_branch Lgr90
Lgs93:
    s_mov_b32 s5, 0x8000
Lp95:
    ds_read_b32 v11, v2 offset:0
    s_waitcnt lgkmcnt(0)
    v_readfirstlane_b32 s4, v11
    s_nop 0
    s_cmp_ge_u32 s4, 16
    s_cbranch_scc1 Lpe96
    s_sub_u32 s5, s5, 1
    s_cmp_lg_u32 s5, 0
    s_cbranch_scc1 Lp95
Lpe96:
    s_branch Lgr94
Lgs97:
    s_mov_b32 s5, 0x8000
Lp99:
    ds_read_b32 v11, v2 offset:0
    s_waitcnt lgkmcnt(0)
    v_readfirstlane_b32 s4, v11
    s_nop 0
    s_cmp_ge_u32 s4, 18
    s_cbranch_scc1 Lpe100
    s_sub_u32 s5, s5, 1
    s_cmp_lg_u32 s5, 0
    s_cbranch_scc1 Lp99
Lpe100:
    s_branch Lgr98
Lgs101:
    s_mov_b32 s5, 0x8000
Lp103:
    ds_read_b32 v11, v2 offset:0
    s_waitcnt lgkmcnt(0)
    v_readfirstlane_b32 s4, v11
    s_nop 0
    s_cmp_ge_u32 s4, 20
    s_cbranch_scc1 Lpe104
    s_sub_u32 s5, s5, 1
    s_cmp_lg_u32 s5, 0
    s_cbranch_scc1 Lp103
Lpe104:
    s_branch Lgr102
Lgs105:
    s_mov_b32 s5, 0x8000
Lp107:
    ds_read_b32 v11, v2 offset:0
    s_waitcnt lgkmcnt(0)
    v_readfirstlane_b32 s4, v11
    s_nop 0
    s_cmp_ge_u32 s4, 22
    s_cbranch_scc1 Lpe108
    s_sub_u32 s5, s5, 1
    s_cmp_lg_u32 s5, 0
    s_cbranch_scc1 Lp107
Lpe108:
    s_branch Lgr106
Lgs109:
    s_mov_b32 s5, 0x8000
Lp111:
    ds_read_b32 v11, v2 offset:0
    s_waitcnt lgkmcnt(0)
    v_readfirstlane_b32 s4, v11
    s_nop 0
    s_cmp_ge_u32 s4, 24
    s_cbranch_scc1 Lpe112
    s_sub_u32 s5, s5, 1
    s_cmp_lg_u32 s5, 0
    s_cbranch_scc1 Lp111
Lpe112:
    s_branch Lgr110
Lgs113:
    s_mov_b32 s5, 0x8000
Lp115:
    ds_read_b32 v11, v2 offset:0
    s_waitcnt lgkmcnt(0)
    v_readfirstlane_b32 s4, v11
    s_nop 0
    s_cmp_ge_u32 s4, 26
    s_cbranch_scc1 Lpe116
    s_sub_u32 s5, s5, 1
    s_cmp_lg_u32 s5, 0
    s_cbranch_scc1 Lp115
Lpe116:
    s_branch Lgr114
Lgs117:
    s_mov_b32 s5, 0x8000
Lp119:
    ds_read_b32 v11, v2 offset:0
    s_waitcnt lgkmcnt(0)
    v_readfirstlane_b32 s4, v11
    s_nop 0
    s_cmp_ge_u32 s4, 28
    s_cbranch_scc1 Lpe120
    s_sub_u32 s5, s5, 1
    s_cmp_lg_u32 s5, 0
    s_cbranch_scc1 Lp119
Lpe120:
    s_branch Lgr118
Lgs121:
    s_mov_b32 s5, 0x8000
Lp123:
    ds_read_b32 v11, v2 offset:0
    s_waitcnt lgkmcnt(0)
    v_readfirstlane_b32 s4, v11
    s_nop 0
    s_cmp_ge_u32 s4, 30
    s_cbranch_scc1 Lpe124
    s_sub_u32 s5, s5, 1
    s_cmp_lg_u32 s5, 0
    s_cbranch_scc1 Lp123
Lpe124:
    s_branch Lgr122
Lgs125:
    s_mov_b32 s5, 0x8000
Lp127:
    ds_read_b32 v11, v2 offset:0
    s_waitcnt lgkmcnt(0)
    v_readfirstlane_b32 s4, v11
    s_nop 0
    s_cmp_ge_u32 s4, 32
    s_cbranch_scc1 Lpe128
    s_sub_u32 s5, s5, 1
    s_cmp_lg_u32 s5, 0
    s_cbranch_scc1 Lp127
Lpe128:
    s_branch Lgr126
Lgs129:
    s_mov_b32 s5, 0x8000
Lp131:
    ds_read_b32 v11, v2 offset:32
    s_waitcnt lgkmcnt(0)
    v_readfirstlane_b32 s4, v11
    s_nop 0
    s_cmp_ge_u32 s4, 1
    s_cbranch_scc1 Lpe132
    s_sub_u32 s5, s5, 1
    s_cmp_lg_u32 s5, 0
    s_cbranch_scc1 Lp131
Lpe132:
    s_branch Lgr130
Lgs138:
    s_mov_b32 s5, 0x8000
Lp140:
    ds_read_b32 v11, v2 offset:0
    s_waitcnt lgkmcnt(0)
    v_readfirstlane_b32 s4, v11
    s_nop 0
    s_cmp_ge_u32 s4, 34
    s_cbranch_scc1 Lpe141
    s_sub_u32 s5, s5, 1
    s_cmp_lg_u32 s5, 0
    s_cbranch_scc1 Lp140
Lpe141:
    s_branch Lgr139
Lgs142:
    s_mov_b32 s5, 0x8000
Lp144:
    ds_read_b32 v11, v2 offset:0
    s_waitcnt lgkmcnt(0)
    v_readfirstlane_b32 s4, v11
    s_nop 0
    s_cmp_ge_u32 s4, 35
    s_cbranch_scc1 Lpe145
    s_sub_u32 s5, s5, 1
    s_cmp_lg_u32 s5, 0
    s_cbranch_scc1 Lp144
Lpe145:
    s_branch Lgr143
Lgs146:
    s_mov_b32 s5, 0x8000
Lp148:
    ds_read_b32 v11, v2 offset:0
    s_waitcnt lgkmcnt(0)
    v_readfirstlane_b32 s4, v11
    s_nop 0
    s_cmp_ge_u32 s4, 36
    s_cbranch_scc1 Lpe149
    s_sub_u32 s5, s5, 1
    s_cmp_lg_u32 s5, 0
    s_cbranch_scc1 Lp148
Lpe149:
    s_branch Lgr147
Lgs150:
    s_mov_b32 s5, 0x8000
Lp152:
    ds_read_b32 v11, v2 offset:92
    s_waitcnt lgkmcnt(0)
    v_readfirstlane_b32 s4, v11
    s_nop 0
    s_cmp_ge_u32 s4, 1
    s_cbranch_scc1 Lpe153
    s_sub_u32 s5, s5, 1
    s_cmp_lg_u32 s5, 0
    s_cbranch_scc1 Lp152
Lpe153:
    s_branch Lgr151
L_exit:
    s_endpgm
L_end:
.section .rodata,"a"
.p2align 6
.amdhsa_kernel recurrent_scan__ssm_conv_s4d__swiglu_ffn__prompt_kernel
  .amdhsa_next_free_vgpr 168
  .amdhsa_next_free_sgpr 100
  .amdhsa_accum_offset 168
  .amdhsa_group_segment_fixed_size 0
  .amdhsa_kernarg_size 112
  .amdhsa_user_sgpr_count 2
  .amdhsa_user_sgpr_kernarg_segment_ptr 1
  .amdhsa_system_sgpr_workgroup_id_x 1
  .amdhsa_float_denorm_mode_32 3
  .amdhsa_float_denorm_mode_16_64 3
.end_amdhsa_kernel
```
